```python
import torch

def _softmax(x, axis=-1):
    return torch.softmax(x, dim=axis)
def _gelu(x):
    return torch.nn.functional.gelu(x, approximate="tanh")
def _silu(x):
    return torch.nn.functional.silu(x)
def _sigmoid(x):
    return torch.sigmoid(x)
def _layernorm(x, axis=-1, eps=1e-5):
    m = x.mean(dim=axis, keepdim=True)
    v = x.var(dim=axis, keepdim=True, unbiased=False)
    return (x - m) / torch.sqrt(v + eps)
def _scatter_add(tgt, idx, src, axis=0):
    return tgt.clone().index_add_(axis, idx, src)
def _segment_sum(src, seg, n):
    out = torch.zeros((n,) + src.shape[1:], dtype=src.dtype)
    return out.index_add_(0, seg, src)
def _pad(x, pw):
    flat = tuple(v for pair in reversed(pw) for v in pair)
    return torch.nn.functional.pad(x, flat)

kernel_name = 'sequential_preLN__compressed_kv_cla__glu_gated_geglu__decode'

def setup_inputs():

    _w = (lambda a: (lambda t: t.to(torch.bfloat16) if t.is_floating_point() else t)(torch.as_tensor(a)))
    def _A_setup():
        B, H, Sq, Sk, D, M = 1, 32, 1, 8192, 128, 640
        Dc = 4 * D
        return {
            "x": _w((lambda *s: torch.randn(*s, dtype=torch.bfloat16) * 0.05)(B, Sq, M)),
            "c_kv": _w((lambda *s: torch.randn(*s, dtype=torch.bfloat16) * 0.8)(B, Sk, Dc)),
            "w_q": _w((lambda *s: torch.randn(*s, dtype=torch.bfloat16) * 1.6)(M, H, D) * (M ** -0.5)),
            "w_uk": _w((lambda *s: torch.randn(*s, dtype=torch.bfloat16) * 1.6)(Dc, H, D) * (Dc ** -0.5)),
            "w_uv": _w((lambda *s: torch.randn(*s, dtype=torch.bfloat16) * 0.8)(Dc, H, D) * (Dc ** -0.5)),
            "w_o": _w((lambda *s: torch.randn(*s, dtype=torch.bfloat16) * 0.8)(H, D, M) * ((H * D) ** -0.5)),
        }
    _A_in = _A_setup()

    def _B_setup():
        B, S, Dm, Df = 1, 1, 640, 1728
        return {
            "x": _w((lambda *s: torch.randn(*s, dtype=torch.bfloat16) * 0.05)(B, S, Dm)),
            "w_gate": _w((lambda *s: torch.randn(*s, dtype=torch.bfloat16) * 0.4)(Dm, Df) * (Dm ** -0.5)),
            "w_up": _w((lambda *s: torch.randn(*s, dtype=torch.bfloat16) * 0.4)(Dm, Df) * (Dm ** -0.5)),
            "w_down": _w((lambda *s: torch.randn(*s, dtype=torch.bfloat16) * 0.4)(Df, Dm) * (Df ** -0.5)),
        }
    _B_in = _B_setup()

    return {
        "A_x": _A_in["x"],
        "A_c_kv": _A_in["c_kv"],
        "A_w_q": _A_in["w_q"],
        "A_w_uk": _A_in["w_uk"],
        "A_w_uv": _A_in["w_uv"],
        "A_w_o": _A_in["w_o"],
        "B_x": _B_in["x"],
        "B_w_gate": _B_in["w_gate"],
        "B_w_up": _B_in["w_up"],
        "B_w_down": _B_in["w_down"],
    }

def reference(A_x, A_c_kv, A_w_q, A_w_uk, A_w_uv, A_w_o, B_x, B_w_gate, B_w_up, B_w_down):
    def _A_ref(x, c_kv, w_q, w_uk, w_uv, w_o):
        B, Sq, M = x.shape[0], x.shape[1], x.shape[2]
        Sk = c_kv.shape[1]
        H, D = w_q.shape[1], w_q.shape[2]
        q = torch.einsum("bqm,mhd->bhqd", x, w_q)
        k = torch.einsum("bkc,chd->bhkd", c_kv, w_uk)
        v = torch.einsum("bkc,chd->bhkd", c_kv, w_uv)
        scores = torch.einsum("bhqd,bhkd->bhqk", q, k) * (D ** -0.5)
        off = Sk - Sq
        qi = torch.arange(Sq)[:, None]
        kj = torch.arange(Sk)[None, :]
        cmask = kj <= (qi + off)
        scores = torch.where(cmask[None, None], scores, -1e9)
        p = _softmax(scores, axis=-1)
        ctx = torch.einsum("bhqk,bhkd->bhqd", p, v)
        return torch.einsum("bhqd,hdm->bqm", ctx, w_o)

    def _B_ref(x, w_gate, w_up, w_down):
        g = torch.einsum("bsd,df->bsf", x, w_gate)
        u = torch.einsum("bsd,df->bsf", x, w_up)
        h = _gelu(g) * u
        return torch.einsum("bsf,fd->bsd", h, w_down)

    x = A_x
    h = x + _A_ref(_layernorm(x, axis=-1), A_c_kv, A_w_q, A_w_uk, A_w_uv, A_w_o)
    h2 = h + _B_ref(_layernorm(h, axis=-1), B_w_gate, B_w_up, B_w_down)
    return h2
```

```asm
; @launch grid=(256,1,1) block=(256,1,1) lds=155648
.amdgcn_target "amdgcn-amd-amdhsa--gfx950"
.text
.globl sequential_preLN__compressed_kv_cla__glu_gated_geglu__decode_kernel
.p2align 8
.type sequential_preLN__compressed_kv_cla__glu_gated_geglu__decode_kernel,@function
sequential_preLN__compressed_kv_cla__glu_gated_geglu__decode_kernel:
  s_cmp_ge_u32 s2, 256
  s_cbranch_scc1 LEND
  s_load_dwordx16 s[36:51], s[0:1], 0
  s_load_dwordx2 s[60:61], s[0:1], 96
  s_load_dwordx8 s[52:59], s[0:1], 64
  s_cmp_ge_u32 s2, 32
  s_cbranch_scc1 LNP
  s_getpc_b64 s[6:7]
LPC:
  v_lshlrev_b32 v7, 7, v0
  v_min_u32 v7, LEND-LPC, v7
  global_load_dword v255, v7, s[6:7]
LNP:
  v_lshrrev_b32 v7, 6, v0
  v_and_b32 v1, 63, v0
  v_readfirstlane_b32 s3, v7
  v_bfe_u32 v2, v0, 4, 2
  v_and_b32 v3, 15, v0
  v_mov_b32 v5, 0xffff
  v_mov_b32 v6, 2146435072
  v_mov_b32 v8, -1
  v_mov_b32 v9, -1
  v_mov_b32 v10, -1
  v_mov_b32 v11, -1
  s_and_b32 s4, s2, 7
  s_lshr_b32 s5, s2, 3
  s_bfe_u32 s28, s2, 0x20005
  s_lshl_b32 s29, s4, 2
  s_add_u32 s28, s28, s29
  s_and_b32 s29, s5, 3
  s_mov_b32 s10, 8388608
  s_mov_b32 s11, 0x20000
  s_cmp_ge_u32 s5, 16
  s_cbranch_scc0 LU
LT:
  s_lshl_b32 s101, s29, 2
  s_add_u32 s101, s101, s3
  s_mov_b32 s98, s101
  s_mov_b32 s99, s28
  v_mul_u32_u24 v108, 20, v1
  s_mul_i32 s97, s98, 327680
  s_lshl_b32 s35, s99, 8
  s_add_u32 s97, s97, s35
  v_mul_u32_u24 v109, 81920, v2
  v_lshl_add_u32 v109, v3, 4, v109
  s_bfe_u32 s30, s2, 0x30004
  s_lshl_b32 s34, s4, 3
  s_add_u32 s30, s30, s34
  s_lshl_b32 s32, s30, 17
  s_lshl_b32 s96, s3, 15
  s_and_b32 s31, s5, 1
  s_lshl_b32 s34, s31, 14
  s_add_u32 s96, s96, s34
  s_add_u32 s32, s32, s96
  s_mov_b32 s100, s96
  v_lshlrev_b32 v16, 4, v1
  s_mov_b32 s14, 1280
  s_mov_b32 s15, 0x20000
  s_mov_b32 s18, 8388608
  s_mov_b32 s19, 0x20000
  s_mov_b32 s22, 5242880
  s_mov_b32 s23, 0x20000
  s_lshl_b32 s63, s28, 2
  s_add_u32 s63, s63, s29
  s_lshl_b32 s34, s63, 8
  s_add_u32 s34, s34, 655360
  v_lshl_add_u32 v111, v3, 4, s34
  v_mul_u32_u24 v36, 32768, v2
  v_add_u32 v111, v111, v36
  s_lshl_b32 s35, s3, 6
  s_add_u32 s34, s34, s35
  v_lshl_add_u32 v13, v3, 2, s34
  v_cmp_gt_u32 vcc, 32, v1
  s_nop 1
  v_cndmask_b32 v111, v6, v111, vcc
  v_xor_b32 v17, 32, v16
  v_xor_b32 v18, 64, v16
  v_xor_b32 v19, 96, v16
  v_xor_b32 v20, 128, v16
  v_xor_b32 v21, 160, v16
  v_xor_b32 v22, 192, v16
  v_xor_b32 v23, 224, v16
  v_xor_b32 v24, 16, v16
  v_xor_b32 v25, 48, v16
  v_xor_b32 v26, 80, v16
  v_xor_b32 v27, 112, v16
  v_xor_b32 v28, 144, v16
  v_xor_b32 v29, 176, v16
  v_xor_b32 v30, 208, v16
  v_xor_b32 v31, 240, v16
  s_waitcnt lgkmcnt(0)
  s_load_dword s62, s[60:61], 0
  s_mov_b32 s12, s36
  s_mov_b32 s13, s37
  s_mov_b32 s20, s40
  s_mov_b32 s21, s41
  buffer_load_dwordx4 v[72:75], v108, s[12:15], 0 offen
  buffer_load_dword v76, v108, s[12:15], 0 offen offset:16
  buffer_load_dwordx4 v[128:131], v109, s[20:23], s97 offen
  s_add_u32 s97, s97, 8192
  buffer_load_dwordx4 v[132:135], v109, s[20:23], s97 offen
  s_add_u32 s97, s97, 8192
  buffer_load_dwordx4 v[136:139], v109, s[20:23], s97 offen
  s_add_u32 s97, s97, 8192
  buffer_load_dwordx4 v[140:143], v109, s[20:23], s97 offen
  s_add_u32 s97, s97, 8192
  buffer_load_dwordx4 v[144:147], v109, s[20:23], s97 offen
  s_add_u32 s97, s97, 8192
  buffer_load_dwordx4 v[148:151], v109, s[20:23], s97 offen
  s_add_u32 s97, s97, 8192
  buffer_load_dwordx4 v[152:155], v109, s[20:23], s97 offen
  s_add_u32 s97, s97, 8192
  buffer_load_dwordx4 v[156:159], v109, s[20:23], s97 offen
  s_add_u32 s97, s97, 8192
  buffer_load_dwordx4 v[160:163], v109, s[20:23], s97 offen
  s_add_u32 s97, s97, 8192
  buffer_load_dwordx4 v[164:167], v109, s[20:23], s97 offen
  s_mov_b32 s16, s38
  s_mov_b32 s17, s39
  s_mov_b32 s8, s60
  s_mov_b32 s9, s61
  s_cmp_lg_u32 s3, 0
  s_cbranch_scc1 Lw_1
  buffer_store_dwordx4 v[8:11], v111, s[8:11], 0 offen sc1
Lw_1:
  s_mov_b32 m0, s100
  s_add_u32 s100, s100, 4096
  buffer_load_dwordx4 v16, s[16:19], s32 offen offset:0  lds
  v_and_b32 v36, 1, v3
  v_lshlrev_b32 v36, 4, v36
  v_lshlrev_b32 v36, v36, v5
  v_bfe_u32 v37, v3, 1, 2
  v_cmp_eq_u32 vcc, 0, v37
  s_nop 1
  v_cndmask_b32 v32, 0, v36, vcc
  v_cmp_eq_u32 vcc, 1, v37
  s_nop 1
  v_cndmask_b32 v33, 0, v36, vcc
  v_cmp_eq_u32 vcc, 2, v37
  s_nop 1
  v_cndmask_b32 v34, 0, v36, vcc
  v_cmp_eq_u32 vcc, 3, v37
  s_nop 1
  v_cndmask_b32 v35, 0, v36, vcc
  s_lshl_b32 s34, s99, 14
  s_lshl_b32 s35, s98, 9
  s_add_u32 s34, s34, s35
  s_add_u32 s34, s34, 1048576
  v_lshlrev_b32 v110, 5, v3
  v_lshl_add_u32 v110, v2, 4, v110
  v_add_u32 v110, s34, v110
  s_lshl_b32 s34, s98, 4
  v_lshl_add_u32 v108, v2, 2, s34
  s_lshl_b32 s35, s31, 2
  s_add_u32 s35, s35, s3
  s_lshl_b32 s97, s35, 7
  s_add_u32 s97, s97, 4096
  v_lshl_add_u32 v14, v3, 10, s97
  s_lshl_b32 s35, s35, 12
  s_add_u32 s35, s35, 589824
  v_add_u32 v15, s35, v16
  v_mov_b32 v94, 0x3f803f80
  s_mov_b32 s27, 524288
  v_cmp_gt_u32 vcc, 32, v1
  s_nop 1
  v_cndmask_b32 v110, v6, v110, vcc
  v_cmp_gt_u32 vcc, 16, v1
  s_nop 1
  v_cndmask_b32 v111, v6, v111, vcc
  s_waitcnt lgkmcnt(0)
  s_add_u32 s62, s62, 1
  s_lshl_b32 s34, s2, 7
  s_add_u32 s34, s34, 4096
  v_mov_b32 v38, s34
  v_mov_b32 v39, s62
  v_cmp_eq_u32 vcc, 0, v0
  s_nop 1
  v_cndmask_b32 v38, v6, v38, vcc
  v_mov_b32 v105, s62
  v_mov_b32 v107, s62
  v_mov_b32 v92, 0
  v_mov_b32 v93, 0
  s_waitcnt vmcnt(11)
  ds_bpermute_b32 v77, v108, v72
  ds_bpermute_b32 v78, v108, v73
  ds_bpermute_b32 v79, v108, v74
  ds_bpermute_b32 v80, v108, v75
  ds_bpermute_b32 v81, v108, v76
  v_dot2c_f32_bf16 v92, v72, v94
  v_dot2c_f32_bf16 v93, v72, v72
  v_dot2c_f32_bf16 v92, v73, v94
  v_dot2c_f32_bf16 v93, v73, v73
  v_dot2c_f32_bf16 v92, v74, v94
  v_dot2c_f32_bf16 v93, v74, v74
  v_dot2c_f32_bf16 v92, v75, v94
  v_dot2c_f32_bf16 v93, v75, v75
  v_dot2c_f32_bf16 v92, v76, v94
  v_dot2c_f32_bf16 v93, v76, v76
  s_nop 1
  v_add_f32_dpp v92, v92, v92 row_ror:8 row_mask:0xf bank_mask:0xf
  v_add_f32_dpp v93, v93, v93 row_ror:8 row_mask:0xf bank_mask:0xf
  s_nop 0
  v_add_f32_dpp v92, v92, v92 row_ror:4 row_mask:0xf bank_mask:0xf
  v_add_f32_dpp v93, v93, v93 row_ror:4 row_mask:0xf bank_mask:0xf
  s_nop 0
  v_add_f32_dpp v92, v92, v92 row_ror:2 row_mask:0xf bank_mask:0xf
  v_add_f32_dpp v93, v93, v93 row_ror:2 row_mask:0xf bank_mask:0xf
  s_nop 0
  v_add_f32_dpp v92, v92, v92 row_ror:1 row_mask:0xf bank_mask:0xf
  v_add_f32_dpp v93, v93, v93 row_ror:1 row_mask:0xf bank_mask:0xf
  s_nop 1
  v_permlane32_swap_b32 v92, v93
  v_add_f32 v92, v92, v93
  v_mov_b32 v93, v92
  s_nop 1
  v_permlane16_swap_b32 v92, v93
  v_add_f32 v92, v92, v93
  v_mov_b32 v93, v92
  s_nop 1
  v_permlane32_swap_b32 v92, v93
  s_waitcnt lgkmcnt(0)
  v_mul_f32 v92, 0x3acccccd, v92
  v_mul_f32 v93, 0x3acccccd, v93
  v_lshlrev_b32 v82, 16, v77
  v_and_b32 v83, 0xffff0000, v77
  v_fma_f32 v93, -v92, v92, v93
  v_lshlrev_b32 v84, 16, v78
  v_and_b32 v85, 0xffff0000, v78
  v_max_f32 v93, 0, v93
  v_lshlrev_b32 v86, 16, v79
  v_and_b32 v87, 0xffff0000, v79
  v_add_f32 v93, 0x3727c5ac, v93
  v_lshlrev_b32 v88, 16, v80
  v_and_b32 v89, 0xffff0000, v80
  v_rsq_f32 v93, v93
  v_lshlrev_b32 v90, 16, v81
  v_and_b32 v91, 0xffff0000, v81
  v_mul_f32 v92, v92, v93
  v_fma_f32 v82, v82, v93, -v92
  v_fma_f32 v83, v83, v93, -v92
  v_fma_f32 v84, v84, v93, -v92
  v_fma_f32 v85, v85, v93, -v92
  v_fma_f32 v86, v86, v93, -v92
  v_fma_f32 v87, v87, v93, -v92
  v_fma_f32 v88, v88, v93, -v92
  v_fma_f32 v89, v89, v93, -v92
  v_fma_f32 v90, v90, v93, -v92
  v_fma_f32 v91, v91, v93, -v92
  v_cvt_pk_bf16_f32 v82, v82, v82
  v_cvt_pk_bf16_f32 v83, v83, v83
  v_cvt_pk_bf16_f32 v84, v84, v84
  v_cvt_pk_bf16_f32 v85, v85, v85
  v_cvt_pk_bf16_f32 v86, v86, v86
  v_cvt_pk_bf16_f32 v87, v87, v87
  v_cvt_pk_bf16_f32 v88, v88, v88
  v_cvt_pk_bf16_f32 v89, v89, v89
  v_cvt_pk_bf16_f32 v90, v90, v90
  v_cvt_pk_bf16_f32 v91, v91, v91
  v_and_b32 v168, v82, v32
  v_and_b32 v169, v82, v33
  v_and_b32 v170, v82, v34
  v_and_b32 v171, v82, v35
  v_and_b32 v172, v83, v32
  v_and_b32 v173, v83, v33
  v_and_b32 v174, v83, v34
  v_and_b32 v175, v83, v35
  v_and_b32 v176, v84, v32
  v_and_b32 v177, v84, v33
  v_and_b32 v178, v84, v34
  v_and_b32 v179, v84, v35
  v_and_b32 v180, v85, v32
  v_and_b32 v181, v85, v33
  v_and_b32 v182, v85, v34
  v_and_b32 v183, v85, v35
  v_and_b32 v184, v86, v32
  v_and_b32 v185, v86, v33
  v_and_b32 v186, v86, v34
  v_and_b32 v187, v86, v35
  v_and_b32 v188, v87, v32
  v_and_b32 v189, v87, v33
  v_and_b32 v190, v87, v34
  v_and_b32 v191, v87, v35
  v_and_b32 v192, v88, v32
  v_and_b32 v193, v88, v33
  v_and_b32 v194, v88, v34
  v_and_b32 v195, v88, v35
  v_and_b32 v196, v89, v32
  v_and_b32 v197, v89, v33
  v_and_b32 v198, v89, v34
  v_and_b32 v199, v89, v35
  v_and_b32 v200, v90, v32
  v_and_b32 v201, v90, v33
  v_and_b32 v202, v90, v34
  v_and_b32 v203, v90, v35
  v_and_b32 v204, v91, v32
  v_and_b32 v205, v91, v33
  v_and_b32 v206, v91, v34
  v_and_b32 v207, v91, v35
  s_waitcnt vmcnt(10)
  v_mfma_f32_16x16x32_bf16 v[96:99], v[168:171], v[128:131], 0
  buffer_load_dwordx4 v17, s[16:19], s32 offen offset:1024  lds
  s_waitcnt vmcnt(10)
  v_mfma_f32_16x16x32_bf16 v[100:103], v[172:175], v[132:135], 0
  buffer_load_dwordx4 v18, s[16:19], s32 offen offset:2048  lds
  s_waitcnt vmcnt(10)
  v_mfma_f32_16x16x32_bf16 v[96:99], v[176:179], v[136:139], v[96:99]
  buffer_load_dwordx4 v19, s[16:19], s32 offen offset:3072  lds
  s_add_u32 s32, s32, 4096
  s_waitcnt vmcnt(10)
  v_mfma_f32_16x16x32_bf16 v[100:103], v[180:183], v[140:143], v[100:103]
  s_waitcnt vmcnt(9)
  v_mfma_f32_16x16x32_bf16 v[96:99], v[184:187], v[144:147], v[96:99]
  s_waitcnt vmcnt(8)
  v_mfma_f32_16x16x32_bf16 v[100:103], v[188:191], v[148:151], v[100:103]
  s_waitcnt vmcnt(7)
  v_mfma_f32_16x16x32_bf16 v[96:99], v[192:195], v[152:155], v[96:99]
  s_waitcnt vmcnt(6)
  v_mfma_f32_16x16x32_bf16 v[100:103], v[196:199], v[156:159], v[100:103]
  s_waitcnt vmcnt(5)
  v_mfma_f32_16x16x32_bf16 v[96:99], v[200:203], v[160:163], v[96:99]
  s_waitcnt vmcnt(4)
  v_mfma_f32_16x16x32_bf16 v[100:103], v[204:207], v[164:167], v[100:103]
  s_nop 7
  v_pk_add_f32 v[96:97], v[96:97], v[100:101]
  v_pk_add_f32 v[98:99], v[98:99], v[102:103]
  v_cvt_pk_bf16_f32 v104, v96, v97
  v_cvt_pk_bf16_f32 v106, v98, v99
  buffer_store_dwordx4 v[104:107], v110, s[8:11], 0 offen
  buffer_store_dwordx4 v[104:107], v110, s[8:11], s27 offen sc1
  s_mov_b32 m0, s100
  s_add_u32 s100, s100, 4096
  buffer_load_dwordx4 v20, s[16:19], s32 offen offset:0  lds
  buffer_load_dwordx4 v21, s[16:19], s32 offen offset:1024  lds
  s_barrier
  s_lshl_b32 s34, s31, 20
  s_lshl_b32 s35, s3, 14
  s_add_u32 s34, s34, s35
  s_lshl_b32 s35, s30, 8
  s_add_u32 s34, s34, s35
  s_add_u32 s34, s34, 2097152
  v_lshl_add_u32 v12, v3, 4, s34
  v_lshl_add_u32 v12, v2, 18, v12
  s_lshl_b32 s35, s3, 8
  v_lshl_add_u32 v36, v2, 12, s35
  v_and_b32 v36, 0, v36
  v_xor_b32 v12, v12, v36
  s_mov_b32 s24, 0x10000
  s_mov_b32 s25, 0x20000
  s_mov_b32 s26, 0x30000
  s_mov_b32 s27, 32768
  v_cmp_gt_u32 vcc, 16, v1
  s_nop 1
  v_cndmask_b32 v13, v6, v13, vcc
  s_mov_b32 s20, s44
  s_mov_b32 s21, s45
  s_mov_b32 s22, 4194304
  s_mov_b32 s23, 0x20000
  v_and_b32 v4, 7, v3
  v_lshrrev_b32 v36, 3, v3
  v_lshl_or_b32 v4, v4, 1, v36
  v_lshlrev_b32 v36, 1, v2
  v_xor_b32 v36, v36, v4
  v_lshlrev_b32 v36, 4, v36
  v_lshl_add_u32 v36, v3, 10, v36
  v_add_u32 v40, s96, v36
  v_add_u32 v44, 131072, v36
  buffer_load_dwordx4 v22, s[16:19], s32 offen offset:2048  lds
  buffer_load_dwordx4 v23, s[16:19], s32 offen offset:3072  lds
  s_add_u32 s32, s32, 4096
  v_xor_b32 v41, 16, v40
  v_xor_b32 v45, 16, v44
  v_xor_b32 v42, 128, v40
  v_xor_b32 v46, 128, v44
  v_xor_b32 v43, 144, v40
  v_xor_b32 v47, 144, v44
  s_mov_b32 m0, s100
  s_add_u32 s100, s100, 4096
  buffer_load_dwordx4 v24, s[16:19], s32 offen offset:0  lds
  buffer_load_dwordx4 v25, s[16:19], s32 offen offset:1024  lds
  v_lshrrev_b32 v36, 2, v1
  v_and_b32 v37, 7, v36
  v_lshrrev_b32 v64, 5, v1
  v_lshl_or_b32 v37, v37, 1, v64
  v_bfe_u32 v64, v1, 1, 1
  v_xor_b32 v37, v37, v64
  v_lshlrev_b32 v37, 4, v37
  v_lshl_add_u32 v37, v36, 10, v37
  v_and_b32 v64, 1, v1
  v_lshl_add_u32 v37, v64, 3, v37
  s_lshl_b32 s35, s3, 8
  s_and_b32 s34, s96, 0x4000
  s_add_u32 s35, s35, s34
  v_add_u32 v48, s35, v37
  buffer_load_dwordx4 v26, s[16:19], s32 offen offset:2048  lds
  buffer_load_dwordx4 v27, s[16:19], s32 offen offset:3072  lds
  s_add_u32 s32, s32, 4096
  v_xor_b32 v49, 32, v48
  v_xor_b32 v50, 64, v48
  v_xor_b32 v51, 96, v48
  v_xor_b32 v52, 128, v48
  v_xor_b32 v53, 160, v48
  v_xor_b32 v54, 192, v48
  v_xor_b32 v55, 224, v48
  s_mov_b32 m0, s100
  s_add_u32 s100, s100, 4096
  buffer_load_dwordx4 v28, s[16:19], s32 offen offset:0  lds
  buffer_load_dwordx4 v29, s[16:19], s32 offen offset:1024  lds
  v_add_u32 v56, 0x10000, v48
  v_add_u32 v57, 0x10000, v49
  v_add_u32 v58, 0x10000, v50
  v_add_u32 v59, 0x10000, v51
  v_add_u32 v60, 0x10000, v52
  v_add_u32 v61, 0x10000, v53
  v_add_u32 v62, 0x10000, v54
  v_add_u32 v63, 0x10000, v55
  buffer_load_dwordx4 v30, s[16:19], s32 offen offset:2048  lds
  buffer_load_dwordx4 v31, s[16:19], s32 offen offset:3072  lds
  s_add_u32 s32, s32, 4096
  s_lshl_b32 s33, s31, 15
  s_sub_u32 s32, s32, s33
  s_sub_u32 s100, s100, s33
  s_and_b32 s35, s3, 1
  s_lshl_b32 s35, s35, 7
  s_lshr_b32 s97, s3, 1
  s_lshl_b32 s97, s97, 4
  s_or_b32 s35, s35, s97
  v_xor_b32 v68, s35, v16
  s_lshl_b32 s35, s3, 12
  s_add_u32 s35, s35, 131072
  v_add_u32 v68, s35, v68
  v_xor_b32 v69, 32, v68
  v_xor_b32 v70, 64, v68
  v_xor_b32 v71, 96, v68
  s_lshl_b32 s101, s101, 18
  s_lshl_b32 s35, s28, 8
  s_add_u32 s101, s101, s35
  v_lshlrev_b32 v5, 4, v3
  v_lshl_add_u32 v4, v2, 13, v5
  s_mov_b32 m0, s100
  s_add_u32 s100, s100, 4096
  s_waitcnt vmcnt(17)
  buffer_load_dwordx4 v16, s[16:19], s32 offen offset:0  lds
  s_waitcnt vmcnt(17)
  buffer_load_dwordx4 v17, s[16:19], s32 offen offset:1024  lds
  s_waitcnt vmcnt(17)
  buffer_load_dwordx4 v18, s[16:19], s32 offen offset:2048  lds
  s_waitcnt vmcnt(17)
  buffer_load_dwordx4 v19, s[16:19], s32 offen offset:3072  lds
  s_add_u32 s32, s32, 4096
  s_mov_b32 m0, s100
  s_add_u32 s100, s100, 4096
  s_waitcnt vmcnt(15)
  buffer_load_dwordx4 v20, s[16:19], s32 offen offset:0  lds
  s_waitcnt vmcnt(15)
  buffer_load_dwordx4 v21, s[16:19], s32 offen offset:1024  lds
  s_waitcnt vmcnt(15)
  buffer_load_dwordx4 v22, s[16:19], s32 offen offset:2048  lds
  s_waitcnt vmcnt(15)
  buffer_load_dwordx4 v23, s[16:19], s32 offen offset:3072  lds
  s_add_u32 s32, s32, 4096
  s_mov_b32 m0, s100
  s_add_u32 s100, s100, 4096
  s_waitcnt vmcnt(15)
  buffer_load_dwordx4 v24, s[16:19], s32 offen offset:0  lds
  buffer_load_dword v7, v14, s[8:11], 0 offen sc1
  s_waitcnt vmcnt(16)
  buffer_load_dwordx4 v25, s[16:19], s32 offen offset:1024  lds
  s_waitcnt vmcnt(16)
  buffer_load_dwordx4 v26, s[16:19], s32 offen offset:2048  lds
  s_waitcnt vmcnt(16)
  buffer_load_dwordx4 v27, s[16:19], s32 offen offset:3072  lds
  s_add_u32 s32, s32, 4096
  s_mov_b32 m0, s100
  s_add_u32 s100, s100, 4096
  s_waitcnt vmcnt(16)
  buffer_load_dwordx4 v28, s[16:19], s32 offen offset:0  lds
  s_waitcnt vmcnt(16)
  buffer_load_dwordx4 v29, s[16:19], s32 offen offset:1024  lds
  s_waitcnt vmcnt(16)
  buffer_load_dwordx4 v30, s[16:19], s32 offen offset:2048  lds
  s_waitcnt vmcnt(16)
  buffer_load_dwordx4 v31, s[16:19], s32 offen offset:3072  lds
  s_add_u32 s32, s32, 4096
  ds_read_b128 v[128:131], v40 offset:0
  ds_read_b128 v[132:135], v41 offset:0
  ds_read_b128 v[136:139], v42 offset:0
  ds_read_b128 v[140:143], v43 offset:0
  ds_read_b128 v[144:147], v40 offset:256
  ds_read_b128 v[148:151], v41 offset:256
  ds_read_b128 v[152:155], v42 offset:256
  ds_read_b128 v[156:159], v43 offset:256
  ds_read_b128 v[160:163], v40 offset:512
  ds_read_b128 v[164:167], v41 offset:512
  ds_read_b128 v[168:171], v42 offset:512
  ds_read_b128 v[172:175], v43 offset:512
  ds_read_b128 v[176:179], v40 offset:768
  ds_read_b128 v[180:183], v41 offset:768
  ds_read_b128 v[184:187], v42 offset:768
  ds_read_b128 v[188:191], v43 offset:768
  s_barrier
  s_cmp_lg_u32 s3, 0
  s_cbranch_scc1 Lw_2
  buffer_store_dword v39, v38, s[8:11], 0 offen sc1
Lw_2:
  ds_read_b64_tr_b16 a[0:1], v48 offset:0
  ds_read_b64_tr_b16 a[4:5], v49 offset:0
  ds_read_b64_tr_b16 a[8:9], v50 offset:0
  ds_read_b64_tr_b16 a[12:13], v51 offset:0
  ds_read_b64_tr_b16 a[16:17], v52 offset:0
  ds_read_b64_tr_b16 a[20:21], v53 offset:0
  ds_read_b64_tr_b16 a[24:25], v54 offset:0
  ds_read_b64_tr_b16 a[28:29], v55 offset:0
  ds_read_b64_tr_b16 a[32:33], v48 offset:32768
  ds_read_b64_tr_b16 a[36:37], v49 offset:32768
  ds_read_b64_tr_b16 a[40:41], v50 offset:32768
  ds_read_b64_tr_b16 a[44:45], v51 offset:32768
  ds_read_b64_tr_b16 a[48:49], v52 offset:32768
  ds_read_b64_tr_b16 a[52:53], v53 offset:32768
  ds_read_b64_tr_b16 a[56:57], v54 offset:32768
  ds_read_b64_tr_b16 a[60:61], v55 offset:32768
  ds_read_b64_tr_b16 a[64:65], v56 offset:0
  ds_read_b64_tr_b16 a[68:69], v57 offset:0
  ds_read_b64_tr_b16 a[72:73], v58 offset:0
  ds_read_b64_tr_b16 a[76:77], v59 offset:0
  ds_read_b64_tr_b16 a[80:81], v60 offset:0
  ds_read_b64_tr_b16 a[84:85], v61 offset:0
  ds_read_b64_tr_b16 a[88:89], v62 offset:0
  ds_read_b64_tr_b16 a[92:93], v63 offset:0
  ds_read_b64_tr_b16 a[96:97], v56 offset:32768
  ds_read_b64_tr_b16 a[100:101], v57 offset:32768
  ds_read_b64_tr_b16 a[104:105], v58 offset:32768
  ds_read_b64_tr_b16 a[108:109], v59 offset:32768
  ds_read_b64_tr_b16 a[112:113], v60 offset:32768
  ds_read_b64_tr_b16 a[116:117], v61 offset:32768
  ds_read_b64_tr_b16 a[120:121], v62 offset:32768
  ds_read_b64_tr_b16 a[124:125], v63 offset:32768
  v_xor_b32 v40, 0x4000, v40
  v_xor_b32 v41, 0x4000, v41
  v_xor_b32 v42, 0x4000, v42
  v_xor_b32 v43, 0x4000, v43
  v_xor_b32 v48, 0x4000, v48
  v_xor_b32 v49, 0x4000, v49
  v_xor_b32 v50, 0x4000, v50
  v_xor_b32 v51, 0x4000, v51
  v_xor_b32 v52, 0x4000, v52
  v_xor_b32 v53, 0x4000, v53
  v_xor_b32 v54, 0x4000, v54
  v_xor_b32 v55, 0x4000, v55
  v_xor_b32 v56, 0x4000, v56
  v_xor_b32 v57, 0x4000, v57
  v_xor_b32 v58, 0x4000, v58
  v_xor_b32 v59, 0x4000, v59
  v_xor_b32 v60, 0x4000, v60
  v_xor_b32 v61, 0x4000, v61
  v_xor_b32 v62, 0x4000, v62
  v_xor_b32 v63, 0x4000, v63
  s_waitcnt vmcnt(3)
  v_cmp_ne_u32 vcc, s62, v7
  s_nop 0
  s_cmp_eq_u64 vcc, 0
  s_cselect_b32 s35, 0, 2146435072
  v_or_b32 v18, s35, v15
  buffer_load_dwordx4 v[72:75], v18, s[8:11], 0 offen offset:0 sc1
  buffer_load_dwordx4 v[76:79], v18, s[8:11], 0 offen offset:1024 sc1
  buffer_load_dwordx4 v[80:83], v18, s[8:11], 0 offen offset:2048 sc1
  buffer_load_dwordx4 v[84:87], v18, s[8:11], 0 offen offset:3072 sc1
  buffer_load_dword v7, v14, s[8:11], 0 offen sc1
  s_waitcnt vmcnt(5)
  ds_read_b128 v[192:195], v40 offset:0
  ds_read_b128 v[196:199], v41 offset:0
  ds_read_b128 v[200:203], v42 offset:0
  ds_read_b128 v[204:207], v43 offset:0
  ds_read_b128 v[208:211], v40 offset:256
  ds_read_b128 v[212:215], v41 offset:256
  ds_read_b128 v[216:219], v42 offset:256
  ds_read_b128 v[220:223], v43 offset:256
  ds_read_b128 v[224:227], v40 offset:512
  ds_read_b128 v[228:231], v41 offset:512
  ds_read_b128 v[232:235], v42 offset:512
  ds_read_b128 v[236:239], v43 offset:512
  ds_read_b128 v[240:243], v40 offset:768
  ds_read_b128 v[244:247], v41 offset:768
  ds_read_b128 v[248:251], v42 offset:768
  ds_read_b128 v[252:255], v43 offset:768
  s_waitcnt vmcnt(0)
  s_cmp_lg_u32 s35, 0
  s_cbranch_scc1 Lt_3
  v_max3_u32 v17, v72, v73, v74
  v_max3_u32 v17, v17, v75, v76
  v_max3_u32 v17, v17, v77, v78
  v_max3_u32 v17, v17, v79, v80
  v_max3_u32 v17, v17, v81, v82
  v_max3_u32 v17, v17, v83, v84
  v_max3_u32 v17, v17, v85, v86
  v_max_u32 v17, v17, v87
  v_cmp_eq_u32 vcc, -1, v17
  s_cbranch_vccnz Lt_4
Lt_5:
  ds_write_b128 v68, v[72:75] offset:0
  ds_write_b128 v69, v[76:79] offset:1024
  ds_write_b128 v70, v[80:83] offset:2048
  ds_write_b128 v71, v[84:87] offset:3072
  buffer_store_dwordx4 v[8:11], v12, s[8:11], 0 offen sc1
  v_xor_b32 v36, 0, v12
  buffer_store_dwordx4 v[8:11], v36, s[8:11], s24 offen sc1
  v_xor_b32 v36, 0, v12
  buffer_store_dwordx4 v[8:11], v36, s[8:11], s25 offen sc1
  v_xor_b32 v36, 0, v12
  buffer_store_dwordx4 v[8:11], v36, s[8:11], s26 offen sc1
  v_mov_b32 v17, v5
  s_waitcnt lgkmcnt(0)
  s_barrier
  ds_read_b128 v[64:67], v44 offset:0
  ds_read_b128 v[68:71], v45 offset:0
  ds_read_b128 v[72:75], v46 offset:0
  ds_read_b128 v[76:79], v47 offset:0
  ds_read_b128 v[80:83], v44 offset:256
  ds_read_b128 v[84:87], v45 offset:256
  ds_read_b128 v[88:91], v46 offset:256
  ds_read_b128 v[92:95], v47 offset:256
  ds_read_b128 v[96:99], v44 offset:512
  ds_read_b128 v[100:103], v45 offset:512
  ds_read_b128 v[104:107], v46 offset:512
  ds_read_b128 v[108:111], v47 offset:512
  ds_read_b128 v[112:115], v44 offset:768
  ds_read_b128 v[116:119], v45 offset:768
  ds_read_b128 v[120:123], v46 offset:768
  ds_read_b128 v[124:127], v47 offset:768
  s_waitcnt lgkmcnt(15)
  v_mfma_f32_16x16x32_bf16 v[8:11], v[128:131], v[64:67], 0
  v_mfma_f32_16x16x32_bf16 v[40:43], v[192:195], v[64:67], 0
  ds_read_b64_tr_b16 a[2:3], v48 offset:0
  s_lshl_b32 s34, s31, 6
  s_add_u32 s34, s34, s30
  s_lshl_b32 s34, s34, 7
  s_waitcnt lgkmcnt(15)
  v_mfma_f32_16x16x32_bf16 v[8:11], v[132:135], v[68:71], v[8:11]
  v_mfma_f32_16x16x32_bf16 v[40:43], v[196:199], v[68:71], v[40:43]
  ds_read_b64_tr_b16 a[6:7], v49 offset:0
  s_add_u32 s34, s34, 622592
  v_lshl_add_u32 v19, v3, 3, s34
  v_lshrrev_b32 v36, 2, v3
  buffer_load_dwordx4 a[128:131], v4, s[20:23], s101 offen
  s_add_u32 s101, s101, 32768
  s_waitcnt lgkmcnt(15)
  v_mfma_f32_16x16x32_bf16 v[8:11], v[136:139], v[72:75], v[8:11]
  v_mfma_f32_16x16x32_bf16 v[40:43], v[200:203], v[72:75], v[40:43]
  ds_read_b64_tr_b16 a[10:11], v50 offset:0
  v_mul_u32_u24 v36, 0, v36
  v_add_u32 v19, v19, v36
  v_cmp_gt_u32 vcc, 16, v0
  s_waitcnt lgkmcnt(15)
  v_mfma_f32_16x16x32_bf16 v[8:11], v[140:143], v[76:79], v[8:11]
  v_mfma_f32_16x16x32_bf16 v[40:43], v[204:207], v[76:79], v[40:43]
  ds_read_b64_tr_b16 a[14:15], v51 offset:0
  v_cndmask_b32 v19, v6, v19, vcc
  s_lshl_b32 s34, s3, 2
  v_add_u32 v20, 151552, v17
  buffer_load_dwordx4 a[132:135], v4, s[20:23], s101 offen
  s_add_u32 s101, s101, 32768
  s_waitcnt lgkmcnt(15)
  v_mfma_f32_16x16x32_bf16 v[8:11], v[144:147], v[80:83], v[8:11]
  v_mfma_f32_16x16x32_bf16 v[40:43], v[208:211], v[80:83], v[40:43]
  ds_read_b64_tr_b16 a[18:19], v52 offset:0
  v_add_u32 v21, s34, v20
  v_add_u32 v22, 147456, v16
  s_lshl_b32 s34, s3, 10
  s_waitcnt lgkmcnt(15)
  v_mfma_f32_16x16x32_bf16 v[8:11], v[148:151], v[84:87], v[8:11]
  v_mfma_f32_16x16x32_bf16 v[40:43], v[212:215], v[84:87], v[40:43]
  ds_read_b64_tr_b16 a[22:23], v53 offset:0
  v_add_u32 v23, s34, v22
  v_mov_b32 v25, s62
  v_mov_b32 v27, s62
  buffer_load_dwordx4 a[136:139], v4, s[20:23], s101 offen
  s_add_u32 s101, s101, 32768
  s_waitcnt lgkmcnt(15)
  v_mfma_f32_16x16x32_bf16 v[8:11], v[152:155], v[88:91], v[8:11]
  v_mfma_f32_16x16x32_bf16 v[40:43], v[216:219], v[88:91], v[40:43]
  ds_read_b64_tr_b16 a[26:27], v54 offset:0
  v_mov_b32 v28, 0x3f803f80
  v_mov_b32 v29, 0x3f803f80
  v_mov_b32 v30, 0x3f803f80
  s_waitcnt lgkmcnt(15)
  v_mfma_f32_16x16x32_bf16 v[8:11], v[156:159], v[92:95], v[8:11]
  v_mfma_f32_16x16x32_bf16 v[40:43], v[220:223], v[92:95], v[40:43]
  ds_read_b64_tr_b16 a[30:31], v55 offset:0
  v_mov_b32 v31, 0x3f803f80
  s_lshr_b32 s34, s28, 4
  s_lshl_b32 s34, s34, 2
  buffer_load_dwordx4 a[140:143], v4, s[20:23], s101 offen
  s_add_u32 s101, s101, 32768
  s_waitcnt lgkmcnt(15)
  v_mfma_f32_16x16x32_bf16 v[8:11], v[160:163], v[96:99], v[8:11]
  v_mfma_f32_16x16x32_bf16 v[40:43], v[224:227], v[96:99], v[40:43]
  ds_read_b64_tr_b16 a[34:35], v48 offset:32768
  s_add_u32 s34, s34, s3
  s_lshl_b32 s34, s34, 11
  s_and_b32 s35, s28, 15
  s_waitcnt lgkmcnt(15)
  v_mfma_f32_16x16x32_bf16 v[8:11], v[164:167], v[100:103], v[8:11]
  v_mfma_f32_16x16x32_bf16 v[40:43], v[228:231], v[100:103], v[40:43]
  ds_read_b64_tr_b16 a[38:39], v49 offset:32768
  s_lshl_b32 s35, s35, 3
  s_add_u32 s34, s34, s35
  s_add_u32 s34, s34, 622592
  buffer_load_dwordx4 a[144:147], v4, s[20:23], s101 offen
  s_add_u32 s101, s101, 32768
  s_waitcnt lgkmcnt(15)
  v_mfma_f32_16x16x32_bf16 v[8:11], v[168:171], v[104:107], v[8:11]
  v_mfma_f32_16x16x32_bf16 v[40:43], v[232:235], v[104:107], v[40:43]
  ds_read_b64_tr_b16 a[42:43], v50 offset:32768
  v_and_b32 v36, 3, v3
  v_lshl_add_u32 v37, v2, 2, v36
  v_lshl_add_u32 v14, v37, 7, s34
  s_waitcnt lgkmcnt(15)
  v_mfma_f32_16x16x32_bf16 v[8:11], v[172:175], v[108:111], v[8:11]
  v_mfma_f32_16x16x32_bf16 v[40:43], v[236:239], v[108:111], v[40:43]
  ds_read_b64_tr_b16 a[46:47], v51 offset:32768
  s_and_b32 s35, s63, 0
  s_lshl_b32 s35, s35, 7
  v_xor_b32 v14, s35, v14
  buffer_load_dwordx4 a[148:151], v4, s[20:23], s101 offen
  s_add_u32 s101, s101, 32768
  s_waitcnt lgkmcnt(15)
  v_mfma_f32_16x16x32_bf16 v[8:11], v[176:179], v[112:115], v[8:11]
  v_mfma_f32_16x16x32_bf16 v[40:43], v[240:243], v[112:115], v[40:43]
  ds_read_b64_tr_b16 a[50:51], v52 offset:32768
  s_lshl_b32 s34, s63, 14
  s_lshl_b32 s35, s3, 12
  s_add_u32 s34, s34, s35
  s_waitcnt lgkmcnt(15)
  v_mfma_f32_16x16x32_bf16 v[8:11], v[180:183], v[116:119], v[8:11]
  v_mfma_f32_16x16x32_bf16 v[40:43], v[244:247], v[116:119], v[40:43]
  ds_read_b64_tr_b16 a[54:55], v53 offset:32768
  s_add_u32 s34, s34, 2097152
  v_lshl_add_u32 v15, v2, 10, s34
  v_add_u32 v15, v15, v17
  buffer_load_dwordx4 a[152:155], v4, s[20:23], s101 offen
  s_add_u32 s101, s101, 32768
  s_waitcnt lgkmcnt(15)
  v_mfma_f32_16x16x32_bf16 v[8:11], v[184:187], v[120:123], v[8:11]
  v_mfma_f32_16x16x32_bf16 v[40:43], v[248:251], v[120:123], v[40:43]
  ds_read_b64_tr_b16 a[58:59], v54 offset:32768
  s_mov_b32 s97, 16384
  s_waitcnt lgkmcnt(15)
  v_mfma_f32_16x16x32_bf16 v[8:11], v[188:191], v[124:127], v[8:11]
  v_mfma_f32_16x16x32_bf16 v[40:43], v[252:255], v[124:127], v[40:43]
  ds_read_b64_tr_b16 a[62:63], v55 offset:32768
  buffer_load_dwordx4 a[156:159], v4, s[20:23], s101 offen
  ds_read_b64_tr_b16 a[66:67], v56 offset:0
  s_nop 3
  v_max3_f32 v24, v8, v9, v10
  v_max3_f32 v36, v40, v41, v42
  v_max3_f32 v24, v24, v11, v43
  v_max_f32 v24, v24, v36
  v_mov_b32 v36, v24
  s_nop 1
  v_permlane32_swap_b32 v24, v36
  v_max_f32 v24, v24, v36
  v_mov_b32 v36, v24
  s_nop 1
  v_permlane16_swap_b32 v24, v36
  v_max_f32 v24, v24, v36
  ds_write_b32 v21, v24
  s_waitcnt vmcnt(8)
  s_waitcnt lgkmcnt(0)
  s_barrier
  ds_read_b128 v[44:47], v20
  ds_read_b64_tr_b16 a[70:71], v57 offset:0
  ds_read_b64_tr_b16 a[74:75], v58 offset:0
  ds_read_b64_tr_b16 a[78:79], v59 offset:0
  ds_read_b64_tr_b16 a[82:83], v60 offset:0
  ds_read_b64_tr_b16 a[86:87], v61 offset:0
  ds_read_b64_tr_b16 a[90:91], v62 offset:0
  ds_read_b64_tr_b16 a[94:95], v63 offset:0
  ds_read_b64_tr_b16 a[98:99], v56 offset:32768
  ds_read_b64_tr_b16 a[102:103], v57 offset:32768
  ds_read_b64_tr_b16 a[106:107], v58 offset:32768
  ds_read_b64_tr_b16 a[110:111], v59 offset:32768
  ds_read_b64_tr_b16 a[114:115], v60 offset:32768
  ds_read_b64_tr_b16 a[118:119], v61 offset:32768
  ds_read_b64_tr_b16 a[122:123], v62 offset:32768
  ds_read_b64_tr_b16 a[126:127], v63 offset:32768
  s_waitcnt lgkmcnt(15)
  v_max3_f32 v24, v44, v45, v46
  v_max_f32 v24, v24, v47
  buffer_store_dwordx2 v[24:25], v19, s[8:11], 0 offen sc1
  v_sub_f32 v68, v8, v24
  v_sub_f32 v69, v9, v24
  v_sub_f32 v70, v10, v24
  v_sub_f32 v71, v11, v24
  v_sub_f32 v72, v40, v24
  v_sub_f32 v73, v41, v24
  v_sub_f32 v74, v42, v24
  v_sub_f32 v75, v43, v24
  v_exp_f32 v68, v68
  v_exp_f32 v69, v69
  v_exp_f32 v70, v70
  v_exp_f32 v71, v71
  v_exp_f32 v72, v72
  v_exp_f32 v73, v73
  v_exp_f32 v74, v74
  v_exp_f32 v75, v75
  v_cvt_pk_bf16_f32 v64, v68, v69
  v_cvt_pk_bf16_f32 v65, v70, v71
  v_cvt_pk_bf16_f32 v66, v72, v73
  v_cvt_pk_bf16_f32 v67, v74, v75
  ds_write_b128 v23, v[64:67]
  s_waitcnt lgkmcnt(0)
  s_barrier
  ds_read_b128 v[96:99], v22 offset:0
  ds_read_b128 v[100:103], v22 offset:1024
  ds_read_b128 v[104:107], v22 offset:2048
  ds_read_b128 v[108:111], v22 offset:3072
  s_waitcnt lgkmcnt(3)
  v_mfma_f32_16x16x32_bf16 v[112:115], v[28:31], v[96:99], 0
  v_mfma_f32_16x16x32_bf16 v[64:67], v[96:99], a[0:3], 0
  v_and_b32 v36, 1, v2
  s_and_b32 s34, s3, 1
  v_mfma_f32_16x16x32_bf16 v[68:71], v[96:99], a[4:7], 0
  s_lshl_b32 s34, s34, 7
  v_lshl_or_b32 v37, v36, 5, s34
  v_mfma_f32_16x16x32_bf16 v[72:75], v[96:99], a[8:11], 0
  v_xor_b32 v37, v37, v17
  v_lshl_add_u32 v37, v2, 8, v37
  v_mfma_f32_16x16x32_bf16 v[76:79], v[96:99], a[12:15], 0
  s_lshl_b32 s34, s3, 13
  v_add_u32 v40, s34, v37
  v_mfma_f32_16x16x32_bf16 v[80:83], v[96:99], a[16:19], 0
  v_xor_b32 v41, 64, v40
  v_lshrrev_b32 v37, 2, v3
  v_mfma_f32_16x16x32_bf16 v[84:87], v[96:99], a[20:23], 0
  v_lshl_add_u32 v36, v37, 1, v36
  v_lshlrev_b32 v36, 5, v36
  v_mfma_f32_16x16x32_bf16 v[88:91], v[96:99], a[24:27], 0
  s_lshl_b32 s34, s3, 6
  v_xor_b32 v36, s34, v36
  v_mfma_f32_16x16x32_bf16 v[92:95], v[96:99], a[28:31], 0
  v_and_b32 v38, 3, v3
  v_lshl_add_u32 v36, v38, 3, v36
  s_waitcnt lgkmcnt(2)
  v_mfma_f32_16x16x32_bf16 v[112:115], v[28:31], v[100:103], v[112:115]
  v_mfma_f32_16x16x32_bf16 v[64:67], v[100:103], a[32:35], v[64:67]
  v_lshl_add_u32 v36, v2, 8, v36
  v_lshl_add_u32 v42, v37, 12, v36
  v_mfma_f32_16x16x32_bf16 v[68:71], v[100:103], a[36:39], v[68:71]
  v_xor_b32 v43, 32, v42
  s_lshl_b32 s34, s3, 8
  v_mfma_f32_16x16x32_bf16 v[72:75], v[100:103], a[40:43], v[72:75]
  s_add_u32 s34, s34, 151808
  v_and_b32 v36, 1, v2
  v_mfma_f32_16x16x32_bf16 v[76:79], v[100:103], a[44:47], v[76:79]
  v_lshl_add_u32 v36, v36, 3, v17
  v_add_u32 v44, s34, v36
  v_mfma_f32_16x16x32_bf16 v[80:83], v[100:103], a[48:51], v[80:83]
  v_lshlrev_b32 v45, 8, v38
  v_lshl_add_u32 v45, v2, 4, v45
  v_mfma_f32_16x16x32_bf16 v[84:87], v[100:103], a[52:55], v[84:87]
  v_add_u32 v45, 151808, v45
  s_lshl_b32 s34, s3, 2
  v_mfma_f32_16x16x32_bf16 v[88:91], v[100:103], a[56:59], v[88:91]
  s_add_u32 s34, s34, 152832
  v_mov_b32 v46, s34
  v_mfma_f32_16x16x32_bf16 v[92:95], v[100:103], a[60:63], v[92:95]
  v_mov_b32 v47, 152832
  s_waitcnt lgkmcnt(1)
  v_mfma_f32_16x16x32_bf16 v[112:115], v[28:31], v[104:107], v[112:115]
  v_mfma_f32_16x16x32_bf16 v[64:67], v[104:107], a[64:67], v[64:67]
  v_mfma_f32_16x16x32_bf16 v[68:71], v[104:107], a[68:71], v[68:71]
  v_mfma_f32_16x16x32_bf16 v[72:75], v[104:107], a[72:75], v[72:75]
  v_mfma_f32_16x16x32_bf16 v[76:79], v[104:107], a[76:79], v[76:79]
  v_mfma_f32_16x16x32_bf16 v[80:83], v[104:107], a[80:83], v[80:83]
  v_mfma_f32_16x16x32_bf16 v[84:87], v[104:107], a[84:87], v[84:87]
  v_mfma_f32_16x16x32_bf16 v[88:91], v[104:107], a[88:91], v[88:91]
  v_mfma_f32_16x16x32_bf16 v[92:95], v[104:107], a[92:95], v[92:95]
  s_waitcnt lgkmcnt(0)
  v_mfma_f32_16x16x32_bf16 v[112:115], v[28:31], v[108:111], v[112:115]
  v_mfma_f32_16x16x32_bf16 v[64:67], v[108:111], a[96:99], v[64:67]
  v_mfma_f32_16x16x32_bf16 v[68:71], v[108:111], a[100:103], v[68:71]
  v_mfma_f32_16x16x32_bf16 v[72:75], v[108:111], a[104:107], v[72:75]
  v_mfma_f32_16x16x32_bf16 v[76:79], v[108:111], a[108:111], v[76:79]
  v_mfma_f32_16x16x32_bf16 v[80:83], v[108:111], a[112:115], v[80:83]
  v_mfma_f32_16x16x32_bf16 v[84:87], v[108:111], a[116:119], v[84:87]
  v_mfma_f32_16x16x32_bf16 v[88:91], v[108:111], a[120:123], v[88:91]
  v_mfma_f32_16x16x32_bf16 v[92:95], v[108:111], a[124:127], v[92:95]
  v_mov_b32 v26, v112
  s_nop 0
  v_cvt_pk_bf16_f32 v128, v64, v68
  s_nop 0
  v_cvt_pk_bf16_f32 v129, v72, v76
  s_nop 0
  v_cvt_pk_bf16_f32 v130, v80, v84
  s_nop 0
  v_cvt_pk_bf16_f32 v131, v88, v92
  buffer_store_dwordx4 v[128:131], v12, s[8:11], 0 offen sc1
  buffer_store_dwordx2 v[26:27], v19, s[8:11], s97 offen sc1
  v_cvt_pk_bf16_f32 v132, v65, v69
  v_cvt_pk_bf16_f32 v133, v73, v77
  v_cvt_pk_bf16_f32 v134, v81, v85
  v_cvt_pk_bf16_f32 v135, v89, v93
  v_xor_b32 v36, 0, v12
  buffer_store_dwordx4 v[132:135], v36, s[8:11], s24 offen sc1
  v_cvt_pk_bf16_f32 v136, v66, v70
  v_cvt_pk_bf16_f32 v137, v74, v78
  v_cvt_pk_bf16_f32 v138, v82, v86
  v_cvt_pk_bf16_f32 v139, v90, v94
  v_xor_b32 v36, 0, v12
  buffer_store_dwordx4 v[136:139], v36, s[8:11], s25 offen sc1
  v_cvt_pk_bf16_f32 v140, v67, v71
  v_cvt_pk_bf16_f32 v141, v75, v79
  v_cvt_pk_bf16_f32 v142, v83, v87
  v_cvt_pk_bf16_f32 v143, v91, v95
  v_xor_b32 v36, 0, v12
  buffer_store_dwordx4 v[140:143], v36, s[8:11], s26 offen sc1
  s_waitcnt vmcnt(6)
  ds_write_b128 v40, a[128:131] offset:0
  ds_write_b128 v40, a[132:135] offset:1024
  ds_write_b128 v40, a[136:139] offset:2048
  ds_write_b128 v40, a[140:143] offset:3072
  ds_write_b128 v41, a[144:147] offset:4096
  ds_write_b128 v41, a[148:151] offset:5120
  ds_write_b128 v41, a[152:155] offset:6144
  ds_write_b128 v41, a[156:159] offset:7168
  s_waitcnt lgkmcnt(0)
  s_barrier
  ds_read_b64_tr_b16 v[160:161], v42 offset:0
  ds_read_b64_tr_b16 v[162:163], v42 offset:16384
  ds_read_b64_tr_b16 v[164:165], v43 offset:0
  ds_read_b64_tr_b16 v[166:167], v43 offset:16384
  ds_read_b64_tr_b16 v[168:169], v42 offset:1024
  ds_read_b64_tr_b16 v[170:171], v42 offset:17408
  ds_read_b64_tr_b16 v[172:173], v43 offset:1024
  ds_read_b64_tr_b16 v[174:175], v43 offset:17408
  ds_read_b64_tr_b16 v[176:177], v42 offset:2048
  ds_read_b64_tr_b16 v[178:179], v42 offset:18432
  ds_read_b64_tr_b16 v[180:181], v43 offset:2048
  ds_read_b64_tr_b16 v[182:183], v43 offset:18432
  ds_read_b64_tr_b16 v[184:185], v42 offset:3072
  ds_read_b64_tr_b16 v[186:187], v42 offset:19456
  ds_read_b64_tr_b16 v[188:189], v43 offset:3072
  ds_read_b64_tr_b16 v[190:191], v43 offset:19456
  s_mov_b32 s33, 32768
Le3s_11:
  s_sub_u32 s33, s33, 1
  s_cbranch_scc1 Le3s_12
  buffer_load_dwordx2 v[48:49], v14, s[8:11], 0 offen sc1
  s_waitcnt vmcnt(0)
  v_cmp_ne_u32 vcc, s62, v49
  s_cbranch_vccnz Le3s_11
Le3s_12:
Lme_10:
  s_mov_b32 s33, 32768
Le3_13:
  s_sub_u32 s33, s33, 1
  s_cbranch_scc1 Le3_14
  buffer_load_dwordx4 v[64:67], v15, s[8:11], 0 offen offset:0 sc1
  buffer_load_dwordx4 v[68:71], v15, s[8:11], 0 offen offset:256 sc1
  buffer_load_dwordx4 v[72:75], v15, s[8:11], 0 offen offset:512 sc1
  buffer_load_dwordx4 v[76:79], v15, s[8:11], 0 offen offset:768 sc1
  buffer_load_dwordx2 v[50:51], v14, s[8:11], s97 offen sc1
  v_max_f32_dpp v52, v48, v48 quad_perm:[1,0,3,2] row_mask:0xf bank_mask:0xf
  s_nop 1
  v_max_f32_dpp v52, v52, v52 quad_perm:[2,3,0,1] row_mask:0xf bank_mask:0xf
  v_mov_b32 v36, v52
  s_nop 1
  v_permlane32_swap_b32 v52, v36
  v_max_f32 v52, v52, v36
  v_mov_b32 v36, v52
  s_nop 1
  v_permlane16_swap_b32 v52, v36
  v_max_f32 v52, v52, v36
  v_sub_f32 v53, v48, v52
  v_exp_f32 v53, v53
  s_nop 0
  v_cvt_pk_bf16_f32 v53, v53, v53
  s_nop 1
  v_and_b32_dpp v80, v53, v32 row_newbcast:0 row_mask:0xf bank_mask:0xf
  v_and_b32_dpp v81, v53, v33 row_newbcast:0 row_mask:0xf bank_mask:0xf
  v_and_b32_dpp v82, v53, v34 row_newbcast:0 row_mask:0xf bank_mask:0xf
  v_and_b32_dpp v83, v53, v35 row_newbcast:0 row_mask:0xf bank_mask:0xf
  v_and_b32_dpp v84, v53, v32 row_newbcast:1 row_mask:0xf bank_mask:0xf
  v_and_b32_dpp v85, v53, v33 row_newbcast:1 row_mask:0xf bank_mask:0xf
  v_and_b32_dpp v86, v53, v34 row_newbcast:1 row_mask:0xf bank_mask:0xf
  v_and_b32_dpp v87, v53, v35 row_newbcast:1 row_mask:0xf bank_mask:0xf
  v_and_b32_dpp v88, v53, v32 row_newbcast:2 row_mask:0xf bank_mask:0xf
  v_and_b32_dpp v89, v53, v33 row_newbcast:2 row_mask:0xf bank_mask:0xf
  v_and_b32_dpp v90, v53, v34 row_newbcast:2 row_mask:0xf bank_mask:0xf
  v_and_b32_dpp v91, v53, v35 row_newbcast:2 row_mask:0xf bank_mask:0xf
  v_and_b32_dpp v92, v53, v32 row_newbcast:3 row_mask:0xf bank_mask:0xf
  v_and_b32_dpp v93, v53, v33 row_newbcast:3 row_mask:0xf bank_mask:0xf
  v_and_b32_dpp v94, v53, v34 row_newbcast:3 row_mask:0xf bank_mask:0xf
  v_and_b32_dpp v95, v53, v35 row_newbcast:3 row_mask:0xf bank_mask:0xf
  v_and_b32 v53, 0xffff0000, v53
  s_waitcnt vmcnt(0)
  v_mfma_f32_16x16x32_bf16 v[56:59], v[80:83], v[64:67], 0
  v_cmp_ne_u32 s[98:99], s62, v51
  v_max3_u32 v7, v64, v65, v66
  v_max3_u32 v7, v7, v67, v68
  v_mfma_f32_16x16x32_bf16 v[60:63], v[84:87], v[68:71], 0
  v_max3_u32 v7, v7, v69, v70
  v_max3_u32 v7, v7, v71, v72
  v_max3_u32 v7, v7, v73, v74
  v_mfma_f32_16x16x32_bf16 v[56:59], v[88:91], v[72:75], v[56:59]
  v_max3_u32 v7, v7, v75, v76
  v_max3_u32 v7, v7, v77, v78
  v_max_u32 v7, v7, v79
  v_mfma_f32_16x16x32_bf16 v[60:63], v[92:95], v[76:79], v[60:63]
  v_cmp_eq_u32 vcc, -1, v7
  s_nop 0
  s_or_b64 vcc, vcc, s[98:99]
  s_cbranch_vccnz Le3_13
Le3_14:
  v_mul_f32 v53, v53, v50
  s_nop 1
  v_add_f32_dpp v53, v53, v53 quad_perm:[1,0,3,2] row_mask:0xf bank_mask:0xf
  s_nop 1
  v_add_f32_dpp v53, v53, v53 quad_perm:[2,3,0,1] row_mask:0xf bank_mask:0xf
  v_mov_b32 v36, v53
  s_nop 1
  v_permlane32_swap_b32 v53, v36
  v_add_f32 v53, v53, v36
  v_mov_b32 v36, v53
  s_nop 1
  v_permlane16_swap_b32 v53, v36
  v_add_f32 v53, v53, v36
  ds_write2_b32 v46, v52, v53 offset0:0 offset1:4
  v_pk_add_f32 v[56:57], v[56:57], v[60:61]
  v_pk_add_f32 v[58:59], v[58:59], v[62:63]
  v_cvt_pk_bf16_f32 v56, v56, v57
  v_cvt_pk_bf16_f32 v57, v58, v59
  ds_write_b64 v44, v[56:57]
  s_waitcnt lgkmcnt(0)
  s_barrier
  ds_read_b128 v[64:67], v45
  ds_read_b128 v[80:83], v47
  ds_read_b128 v[68:71], v45 offset:64
  ds_read_b128 v[84:87], v47 offset:16
  ds_read_b128 v[72:75], v45 offset:128
  ds_read_b128 v[76:79], v45 offset:192
  s_waitcnt lgkmcnt(5)
  v_mfma_f32_16x16x32_bf16 v[56:59], v[64:67], v[160:163], 0
  s_waitcnt lgkmcnt(4)
  v_max3_f32 v52, v80, v81, v82
  v_mfma_f32_16x16x32_bf16 v[60:63], v[64:67], v[164:167], 0
  v_max_f32 v52, v52, v83
  v_sub_f32 v80, v80, v52
  v_sub_f32 v81, v81, v52
  s_waitcnt lgkmcnt(3)
  v_mfma_f32_16x16x32_bf16 v[56:59], v[68:71], v[168:171], v[56:59]
  v_exp_f32 v80, v80
  v_sub_f32 v82, v82, v52
  v_mfma_f32_16x16x32_bf16 v[60:63], v[68:71], v[172:175], v[60:63]
  v_exp_f32 v81, v81
  v_sub_f32 v83, v83, v52
  s_waitcnt lgkmcnt(1)
  v_mfma_f32_16x16x32_bf16 v[56:59], v[72:75], v[176:179], v[56:59]
  v_exp_f32 v82, v82
  v_mul_f32 v53, v80, v84
  v_mfma_f32_16x16x32_bf16 v[60:63], v[72:75], v[180:183], v[60:63]
  v_exp_f32 v83, v83
  v_fmac_f32 v53, v81, v85
  s_waitcnt lgkmcnt(0)
  v_mfma_f32_16x16x32_bf16 v[56:59], v[76:79], v[184:187], v[56:59]
  v_fmac_f32 v53, v82, v86
  v_fmac_f32 v53, v83, v87
  v_mfma_f32_16x16x32_bf16 v[60:63], v[76:79], v[188:191], v[60:63]
  v_rcp_f32 v53, v53
  s_nop 3
  v_pk_mul_f32 v[56:57], v[56:57], v[80:81]
  v_pk_fma_f32 v[56:57], v[58:59], v[82:83], v[56:57]
  s_nop 0
  v_pk_mul_f32 v[60:61], v[60:61], v[80:81]
  v_add_f32 v54, v56, v57
  v_pk_fma_f32 v[60:61], v[62:63], v[82:83], v[60:61]
  v_mul_f32 v54, v54, v53
  v_add_f32 v55, v60, v61
  v_mul_f32 v55, v55, v53
  v_cvt_pk_bf16_f32 v54, v54, v55
  buffer_store_dword v54, v13, s[8:11], 0 offen
  buffer_store_dword v54, v13, s[8:11], s27 offen sc1
  s_endpgm
Lt_3:
  v_cmp_ne_u32 vcc, s62, v7
  s_cbranch_vccz Lt_4
  s_mov_b32 s33, 32768
Ltf_6:
  s_sub_u32 s33, s33, 1
  s_cbranch_scc1 Ltf_7
  buffer_load_dword v7, v14, s[8:11], 0 offen sc1
  s_waitcnt vmcnt(0)
  v_cmp_ne_u32 vcc, s62, v7
  s_cbranch_vccnz Ltf_6
Ltf_7:
Lt_4:
  s_mov_b32 s33, 32768
Le2_8:
  s_sub_u32 s33, s33, 1
  s_cbranch_scc1 Le2_9
  buffer_load_dwordx4 v[72:75], v15, s[8:11], 0 offen offset:0 sc1
  buffer_load_dwordx4 v[76:79], v15, s[8:11], 0 offen offset:1024 sc1
  buffer_load_dwordx4 v[80:83], v15, s[8:11], 0 offen offset:2048 sc1
  buffer_load_dwordx4 v[84:87], v15, s[8:11], 0 offen offset:3072 sc1
  s_waitcnt vmcnt(0)
  v_max3_u32 v17, v72, v73, v74
  v_max3_u32 v17, v17, v75, v76
  v_max3_u32 v17, v17, v77, v78
  v_max3_u32 v17, v17, v79, v80
  v_max3_u32 v17, v17, v81, v82
  v_max3_u32 v17, v17, v83, v84
  v_max3_u32 v17, v17, v85, v86
  v_max_u32 v17, v17, v87
  v_cmp_eq_u32 vcc, -1, v17
  s_cbranch_vccnz Le2_8
Le2_9:
  s_branch Lt_5
  .p2align 6
LU:
  s_lshl_b32 s30, s29, 2
  s_add_u32 s30, s30, s3
  s_lshl_b32 s34, s28, 8
  s_lshl_b32 s32, s30, 18
  s_add_u32 s32, s32, s34
  v_lshrrev_b32 v15, 5, v1
  v_xor_b32 v15, v15, v3
  v_lshlrev_b32 v15, 4, v15
  v_lshl_add_u32 v208, v2, 13, v15
  s_mul_i32 s99, s30, 327680
  s_add_u32 s99, s99, s34
  s_add_u32 s99, s99, 81920
  v_mul_u32_u24 v108, 20, v1
  v_mul_u32_u24 v109, 81920, v2
  v_lshl_add_u32 v109, v3, 4, v109
  s_lshl_b32 s34, s28, 14
  s_add_u32 s34, s34, 1048576
  s_lshl_b32 s35, s3, 7
  s_add_u32 s35, s35, s34
  v_lshlrev_b32 v16, 9, v3
  v_lshl_add_u32 v16, v2, 5, v16
  v_add_u32 v16, s35, v16
  v_add_u32 v17, 8192, v16
  s_lshl_b32 s35, s30, 9
  s_add_u32 s98, s34, s35
  s_lshl_b32 s100, s3, 13
  v_xor_b32 v209, 32, v208
  v_xor_b32 v210, 64, v208
  v_xor_b32 v211, 96, v208
  v_xor_b32 v212, 128, v208
  v_xor_b32 v213, 160, v208
  v_xor_b32 v214, 192, v208
  v_xor_b32 v215, 224, v208
  v_lshrrev_b32 v115, 1, v1
  v_lshl_add_u32 v115, v115, 13, s32
  v_and_b32 v15, 1, v1
  v_lshl_add_u32 v115, v15, 7, v115
  s_waitcnt lgkmcnt(0)
  s_load_dword s62, s[60:61], 0
  s_mov_b32 s12, s36
  s_mov_b32 s13, s37
  s_mov_b32 s14, 1280
  s_mov_b32 s15, 0x20000
  s_mov_b32 s8, s60
  s_mov_b32 s9, s61
  s_mov_b32 s20, s42
  s_mov_b32 s21, s43
  s_mov_b32 s22, 4194304
  s_mov_b32 s23, 0x20000
  buffer_load_dword v26, v16, s[8:11], 0 offen sc1
  s_lshl_b32 s34, s28, 10
  s_lshl_b32 s35, s30, 6
  s_add_u32 s34, s34, s35
  s_add_u32 s34, s34, 589824
  v_lshl_add_u32 v18, v3, 2, s34
  v_cmp_gt_u32 vcc, 16, v1
  s_nop 1
  v_cndmask_b32 v18, v6, v18, vcc
  s_lshl_b32 s63, s4, 3
  s_add_u32 s63, s63, s5
  s_lshl_b32 s96, s63, 8
  s_add_u32 s96, s96, 917504
  s_sub_u32 s63, s63, 8
  s_mul_i32 s34, s63, 1280
  s_add_u32 s34, s34, 786432
  s_cmp_lt_u32 s63, 54
  s_cselect_b32 s35, 1280, 0
  s_cmp_lt_u32 s5, 8
  s_cselect_b32 s96, s96, s34
  s_cselect_b32 s35, 256, s35
  s_lshl_b32 s34, s28, 10
  s_lshl_b32 s97, s29, 8
  s_add_u32 s34, s34, s97
  s_add_u32 s34, s34, 589568
  s_add_u32 s97, s96, 1024
  s_cmp_eq_u32 s35, 1280
  s_cselect_b32 s97, s97, 2146435072
  s_min_u32 s35, s35, 1024
  v_lshlrev_b32 v27, 4, v0
  v_cmp_gt_u32 vcc, s35, v27
  v_add_u32 v19, s96, v27
  s_nop 0
  v_cndmask_b32 v19, v6, v19, vcc
  v_add_u32 v60, s97, v27
  v_add_u32 v61, s34, v27
  v_cmp_gt_u32 vcc, 16, v0
  s_nop 1
  v_cndmask_b32 v60, v61, v60, vcc
  v_cmp_gt_u32 vcc, 32, v0
  s_nop 1
  v_cndmask_b32 v60, v6, v60, vcc
  s_lshl_b32 s34, s3, 3
  s_add_u32 s34, s34, s5
  s_cmp_lt_u32 s34, 8
  s_cselect_b64 vcc, -1, 0
  v_lshl_add_u32 v63, v2, 14, s96
  v_lshl_add_u32 v63, v3, 4, v63
  v_cndmask_b32 v19, v19, v63, vcc
  v_add_u32 v63, 0x10000, v63
  v_cndmask_b32 v63, v6, v63, vcc
  s_cmp_lg_u32 s3, 0
  s_cbranch_scc1 Lw_15
  buffer_store_dwordx4 v[8:11], v60, s[8:11], 0 offen sc1
  buffer_store_dwordx4 v[8:11], v19, s[8:11], 0 offen sc1
  buffer_store_dwordx4 v[8:11], v63, s[8:11], 0 offen sc1
Lw_15:
  v_and_b32 v36, 1, v3
  v_lshlrev_b32 v36, 4, v36
  v_lshlrev_b32 v36, v36, v5
  v_bfe_u32 v37, v3, 1, 2
  v_cmp_eq_u32 vcc, 0, v37
  s_nop 1
  v_cndmask_b32 v32, 0, v36, vcc
  v_cmp_eq_u32 vcc, 1, v37
  s_nop 1
  v_cndmask_b32 v33, 0, v36, vcc
  v_cmp_eq_u32 vcc, 2, v37
  s_nop 1
  v_cndmask_b32 v34, 0, v36, vcc
  v_cmp_eq_u32 vcc, 3, v37
  s_nop 1
  v_cndmask_b32 v35, 0, v36, vcc
  s_waitcnt lgkmcnt(0)
  s_add_u32 s62, s62, 1
  s_lshl_b32 s34, s2, 7
  s_add_u32 s34, s34, 4096
  v_mov_b32 v38, s34
  v_mov_b32 v39, s62
  v_cmp_eq_u32 vcc, 0, v0
  s_nop 1
  v_cndmask_b32 v38, v6, v38, vcc
  s_lshl_b32 s34, s3, 13
  v_xor_b32 v40, v2, v3
  v_lshlrev_b32 v40, 4, v40
  v_lshl_add_u32 v40, v3, 9, v40
  v_add_u32 v40, s34, v40
  v_xor_b32 v41, 64, v40
  v_xor_b32 v42, 128, v40
  v_xor_b32 v43, 192, v40
  s_lshl_b32 s34, s3, 10
  v_lshlrev_b32 v44, 4, v1
  v_add_u32 v45, s34, v44
  v_add_u32 v45, 0x8000, v45
  s_mov_b32 s35, 524288
  s_mov_b32 m0, s100
  s_add_u32 s100, s100, 1024
  buffer_load_dwordx4 v208, s[20:23], s32 offen  lds
  s_add_u32 s32, s32, 32768
  s_mov_b32 m0, s100
  s_add_u32 s100, s100, 1024
  buffer_load_dwordx4 v209, s[20:23], s32 offen  lds
  s_add_u32 s32, s32, 32768
  s_mov_b32 m0, s100
  s_add_u32 s100, s100, 1024
  buffer_load_dwordx4 v210, s[20:23], s32 offen  lds
  s_add_u32 s32, s32, 32768
  s_mov_b32 m0, s100
  s_add_u32 s100, s100, 1024
  buffer_load_dwordx4 v211, s[20:23], s32 offen  lds
  s_add_u32 s32, s32, 32768
  s_mov_b32 m0, s100
  s_add_u32 s100, s100, 1024
  buffer_load_dwordx4 v212, s[20:23], s32 offen  lds
  s_add_u32 s32, s32, 32768
  s_mov_b32 m0, s100
  s_add_u32 s100, s100, 1024
  buffer_load_dwordx4 v213, s[20:23], s32 offen  lds
  s_add_u32 s32, s32, 32768
  s_mov_b32 m0, s100
  s_add_u32 s100, s100, 1024
  buffer_load_dwordx4 v214, s[20:23], s32 offen  lds
  s_add_u32 s32, s32, 32768
  s_mov_b32 m0, s100
  s_add_u32 s100, s100, 1024
  buffer_load_dwordx4 v215, s[20:23], s32 offen  lds
  s_cmp_lg_u32 s3, 0
  s_cbranch_scc1 Lw_16
  s_waitcnt vmcnt(8)
  buffer_store_dword v39, v38, s[8:11], 0 offen sc1
Lw_16:
  v_add_u32 v12, 0, v1
  v_mul_u32_u24 v13, 5462, v12
  v_lshrrev_b32 v13, 16, v13
  v_mul_u32_u24 v14, 12, v13
  v_sub_u32 v12, v12, v14
  v_lshrrev_b32 v14, 1, v13
  v_and_b32 v15, 2, v14
  v_xor_b32 v12, v12, v15
  v_and_b32 v14, 1, v14
  v_and_or_b32 v14, v13, 12, v14
  v_and_b32 v13, 1, v13
  v_lshl_add_u32 v14, v13, 4, v14
  v_mul_u32_u24 v14, 1280, v14
  v_lshl_add_u32 v112, v12, 4, v14
  v_add_u32 v12, 64, v1
  v_mul_u32_u24 v13, 5462, v12
  v_lshrrev_b32 v13, 16, v13
  v_mul_u32_u24 v14, 12, v13
  v_sub_u32 v12, v12, v14
  v_lshrrev_b32 v14, 1, v13
  v_and_b32 v15, 2, v14
  v_xor_b32 v12, v12, v15
  v_and_b32 v14, 1, v14
  v_and_or_b32 v14, v13, 12, v14
  v_and_b32 v13, 1, v13
  v_lshl_add_u32 v14, v13, 4, v14
  v_mul_u32_u24 v14, 1280, v14
  v_lshl_add_u32 v113, v12, 4, v14
  v_add_u32 v12, 128, v1
  v_mul_u32_u24 v13, 5462, v12
  v_lshrrev_b32 v13, 16, v13
  v_mul_u32_u24 v14, 12, v13
  v_sub_u32 v12, v12, v14
  v_lshrrev_b32 v14, 1, v13
  v_and_b32 v15, 2, v14
  v_xor_b32 v12, v12, v15
  v_and_b32 v14, 1, v14
  v_and_or_b32 v14, v13, 12, v14
  v_and_b32 v13, 1, v13
  v_lshl_add_u32 v14, v13, 4, v14
  v_mul_u32_u24 v14, 1280, v14
  v_lshl_add_u32 v114, v12, 4, v14
  s_waitcnt vmcnt(0)
  ds_read_b128 v[64:67], v40 offset:0
  ds_read_b128 v[68:71], v41 offset:0
  ds_read_b128 v[72:75], v42 offset:0
  ds_read_b128 v[76:79], v43 offset:0
  ds_read_b128 v[80:83], v40 offset:256
  ds_read_b128 v[84:87], v41 offset:256
  ds_read_b128 v[88:91], v42 offset:256
  ds_read_b128 v[92:95], v43 offset:256
  s_cmp_ge_u32 s5, 8
  s_cbranch_scc1 LFZ
  s_mov_b32 s24, s46
  s_mov_b32 s25, s47
  s_mov_b32 s26, 5242880
  s_mov_b32 s27, 0x20000
  s_lshl_b32 s28, s4, 2
  s_add_u32 s28, s28, s3
  s_mul_i32 s31, s28, 163840
  s_mul_i32 s34, s5, 160
  s_and_b32 s97, s34, 32
  s_sub_u32 s34, s34, s97
  s_add_u32 s31, s31, s34
  s_mul_i32 s34, s3, 24576
  s_add_u32 s34, s34, 40960
  s_mov_b32 s30, s34
  s_mov_b32 s32, 4096
Le1_17:
  s_mov_b32 s33, 64
Le1_20:
  s_sub_u32 s33, s33, 1
  s_cbranch_scc1 Le1_19
  buffer_load_dwordx4 v[20:23], v16, s[8:11], 0 offen sc1
  buffer_load_dwordx4 v[24:27], v16, s[8:11], 0 offen offset:16 sc1
  s_waitcnt vmcnt(0)
  v_xor_b32 v46, s62, v21
  v_xor_b32 v47, s62, v23
  v_xor_b32 v28, s62, v25
  v_xor_b32 v29, s62, v27
  v_or3_b32 v46, v46, v47, v28
  v_or_b32 v46, v46, v29
  v_cmp_ne_u32 vcc, 0, v46
  s_cbranch_vccnz Le1_20
Le1_18:
  ds_write2_b32 v45, v20, v22 offset0:0 offset1:1
  ds_write2_b32 v45, v24, v26 offset0:2 offset1:3
  s_waitcnt lgkmcnt(0)
  s_barrier
  ds_read_b128 v[128:131], v44 offset:32768
  ds_read_b128 v[132:135], v44 offset:33792
  ds_read_b128 v[136:139], v44 offset:34816
  ds_read_b128 v[140:143], v44 offset:35840
  s_waitcnt lgkmcnt(3)
  v_mfma_f32_16x16x32_bf16 v[48:51], v[128:131], v[64:67], 0
  v_mfma_f32_16x16x32_bf16 v[52:55], v[128:131], v[80:83], 0
  s_waitcnt lgkmcnt(2)
  v_mfma_f32_16x16x32_bf16 v[48:51], v[132:135], v[68:71], v[48:51]
  v_mfma_f32_16x16x32_bf16 v[52:55], v[132:135], v[84:87], v[52:55]
  s_waitcnt lgkmcnt(1)
  v_mfma_f32_16x16x32_bf16 v[48:51], v[136:139], v[72:75], v[48:51]
  v_mfma_f32_16x16x32_bf16 v[52:55], v[136:139], v[88:91], v[52:55]
  s_waitcnt lgkmcnt(0)
  v_mfma_f32_16x16x32_bf16 v[48:51], v[140:143], v[76:79], v[48:51]
  v_mfma_f32_16x16x32_bf16 v[52:55], v[140:143], v[92:95], v[52:55]
  s_nop 6
  v_add_f32 v48, v48, v49
  v_add_f32 v50, v50, v51
  v_add_f32 v52, v52, v53
  v_add_f32 v54, v54, v55
  v_add_f32 v48, v48, v50
  v_add_f32 v52, v52, v54
  s_nop 1
  v_permlane32_swap_b32 v48, v52
  v_add_f32 v48, v48, v52
  v_mov_b32 v49, v48
  s_nop 1
  v_permlane16_swap_b32 v48, v49
  v_add_f32 v48, v48, v49
  v_mul_f32 v48, 0x3e0293ee, v48
  v_mov_b32 v49, v48
  s_nop 1
  v_permlane32_swap_b32 v48, v49
  v_cvt_pk_bf16_f32 v48, v48, v49
  buffer_store_dword v48, v18, s[8:11], 0 offen sc1
  s_mov_b32 s46, 4194304
  s_mov_b32 s47, 0x20000
  buffer_load_dword v116, v115, s[44:47], 0 offen offset:0
  s_mov_b32 m0, s34
  s_add_u32 s34, s34, 1024
  buffer_load_dwordx4 v112, s[24:27], s31 offen  lds
  s_mov_b32 m0, s34
  s_add_u32 s34, s34, 1024
  buffer_load_dwordx4 v113, s[24:27], s31 offen  lds
  s_mov_b32 m0, s34
  s_add_u32 s34, s34, 1024
  buffer_load_dwordx4 v114, s[24:27], s31 offen  lds
  s_add_u32 s31, s31, 2560
  s_mov_b32 m0, s34
  s_add_u32 s34, s34, 1024
  buffer_load_dwordx4 v112, s[24:27], s31 offen  lds
  s_mov_b32 m0, s34
  s_add_u32 s34, s34, 1024
  buffer_load_dwordx4 v113, s[24:27], s31 offen  lds
  s_mov_b32 m0, s34
  s_add_u32 s34, s34, 1024
  buffer_load_dwordx4 v114, s[24:27], s31 offen  lds
  s_add_u32 s31, s31, 38400
  s_mov_b32 m0, s34
  s_add_u32 s34, s34, 1024
  buffer_load_dwordx4 v112, s[24:27], s31 offen  lds
  s_mov_b32 m0, s34
  s_add_u32 s34, s34, 1024
  buffer_load_dwordx4 v113, s[24:27], s31 offen  lds
  s_mov_b32 m0, s34
  s_add_u32 s34, s34, 1024
  buffer_load_dwordx4 v114, s[24:27], s31 offen  lds
  s_add_u32 s31, s31, 2560
  s_mov_b32 m0, s34
  s_add_u32 s34, s34, 1024
  buffer_load_dwordx4 v112, s[24:27], s31 offen  lds
  s_mov_b32 m0, s34
  s_add_u32 s34, s34, 1024
  buffer_load_dwordx4 v113, s[24:27], s31 offen  lds
  s_mov_b32 m0, s34
  s_add_u32 s34, s34, 1024
  buffer_load_dwordx4 v114, s[24:27], s31 offen  lds
  s_add_u32 s31, s31, 38400
  s_mov_b32 m0, s34
  s_add_u32 s34, s34, 1024
  buffer_load_dwordx4 v112, s[24:27], s31 offen  lds
  s_mov_b32 m0, s34
  s_add_u32 s34, s34, 1024
  buffer_load_dwordx4 v113, s[24:27], s31 offen  lds
  s_mov_b32 m0, s34
  s_add_u32 s34, s34, 1024
  buffer_load_dwordx4 v114, s[24:27], s31 offen  lds
  s_add_u32 s31, s31, 2560
  s_mov_b32 m0, s34
  s_add_u32 s34, s34, 1024
  buffer_load_dwordx4 v112, s[24:27], s31 offen  lds
  s_mov_b32 m0, s34
  s_add_u32 s34, s34, 1024
  buffer_load_dwordx4 v113, s[24:27], s31 offen  lds
  s_mov_b32 m0, s34
  s_add_u32 s34, s34, 1024
  buffer_load_dwordx4 v114, s[24:27], s31 offen  lds
  s_add_u32 s31, s31, 38400
  s_mov_b32 m0, s34
  s_add_u32 s34, s34, 1024
  buffer_load_dwordx4 v112, s[24:27], s31 offen  lds
  s_mov_b32 m0, s34
  s_add_u32 s34, s34, 1024
  buffer_load_dwordx4 v113, s[24:27], s31 offen  lds
  s_mov_b32 m0, s34
  s_add_u32 s34, s34, 1024
  buffer_load_dwordx4 v114, s[24:27], s31 offen  lds
  s_add_u32 s31, s31, 2560
  s_mov_b32 m0, s34
  s_add_u32 s34, s34, 1024
  buffer_load_dwordx4 v112, s[24:27], s31 offen  lds
  s_mov_b32 m0, s34
  s_add_u32 s34, s34, 1024
  buffer_load_dwordx4 v113, s[24:27], s31 offen  lds
  s_mov_b32 m0, s34
  s_add_u32 s34, s34, 1024
  buffer_load_dwordx4 v114, s[24:27], s31 offen  lds
  v_lshrrev_b32 v13, 2, v1
  v_mul_u32_u24 v13, 192, v13
  v_and_b32 v12, 3, v3
  v_lshl_add_u32 v13, v12, 3, v13
  v_add_u32 v13, s30, v13
  v_and_b32 v20, 1, v2
  v_lshlrev_b32 v20, 5, v20
  s_add_u32 s34, s97, 32
  v_xor_b32 v21, s34, v20
  v_xor_b32 v20, s97, v20
  v_add_u32 v21, v21, v13
  v_add_u32 v20, v20, v13
  s_lshl_b32 s34, s3, 5
  s_add_u32 s34, s34, s4
  s_add_u32 s34, s34, 128
  s_lshl_b32 s34, s34, 7
  s_add_u32 s34, s34, 4096
  v_lshl_add_u32 v14, v12, 10, s34
  s_lshl_b32 s34, s28, 10
  s_add_u32 s34, s34, 655360
  v_lshlrev_b32 v15, 8, v3
  v_lshl_add_u32 v15, v2, 4, v15
  v_add_u32 v15, s34, v15
  s_mov_b32 s35, 32768
  s_lshl_b32 s34, s3, 2
  v_lshl_add_u32 v16, v3, 4, s34
  v_lshlrev_b32 v17, 5, v1
  v_lshl_add_u32 v18, v1, 2, s96
  s_lshl_b32 s34, s3, 14
  v_add_u32 v18, s34, v18
  s_mov_b32 s31, 0x10000
  v_cmp_gt_u32 vcc, 4, v3
  s_nop 1
  v_cndmask_b32 v15, v6, v15, vcc
  v_cmp_gt_u32 vcc, 40, v1
  s_nop 1
  v_cndmask_b32 v18, v6, v18, vcc
  buffer_load_dword v19, v14, s[8:11], 0 offen sc1
  s_waitcnt vmcnt(1)
  ds_read_b64_tr_b16 v[64:65], v20 offset:0
  ds_read_b64_tr_b16 v[66:67], v20 offset:3072
  ds_read_b64_tr_b16 v[68:69], v21 offset:0
  ds_read_b64_tr_b16 v[70:71], v21 offset:3072
  ds_read_b64_tr_b16 v[72:73], v20 offset:64
  ds_read_b64_tr_b16 v[74:75], v20 offset:3136
  ds_read_b64_tr_b16 v[76:77], v21 offset:64
  ds_read_b64_tr_b16 v[78:79], v21 offset:3136
  ds_read_b64_tr_b16 v[80:81], v20 offset:128
  ds_read_b64_tr_b16 v[82:83], v20 offset:3200
  ds_read_b64_tr_b16 v[84:85], v20 offset:6144
  ds_read_b64_tr_b16 v[86:87], v20 offset:9216
  ds_read_b64_tr_b16 v[88:89], v21 offset:6144
  ds_read_b64_tr_b16 v[90:91], v21 offset:9216
  ds_read_b64_tr_b16 v[92:93], v20 offset:6208
  ds_read_b64_tr_b16 v[94:95], v20 offset:9280
  ds_read_b64_tr_b16 v[96:97], v21 offset:6208
  ds_read_b64_tr_b16 v[98:99], v21 offset:9280
  ds_read_b64_tr_b16 v[100:101], v20 offset:6272
  ds_read_b64_tr_b16 v[102:103], v20 offset:9344
  ds_read_b64_tr_b16 v[104:105], v20 offset:12288
  ds_read_b64_tr_b16 v[106:107], v20 offset:15360
  ds_read_b64_tr_b16 v[108:109], v21 offset:12288
  ds_read_b64_tr_b16 v[110:111], v21 offset:15360
  ds_read_b64_tr_b16 v[112:113], v20 offset:12352
  ds_read_b64_tr_b16 v[114:115], v20 offset:15424
  ds_read_b64_tr_b16 v[116:117], v21 offset:12352
  ds_read_b64_tr_b16 v[118:119], v21 offset:15424
  ds_read_b64_tr_b16 v[120:121], v20 offset:12416
  ds_read_b64_tr_b16 v[122:123], v20 offset:15488
  ds_read_b64_tr_b16 v[124:125], v20 offset:18432
  ds_read_b64_tr_b16 v[126:127], v20 offset:21504
  ds_read_b64_tr_b16 v[128:129], v21 offset:18432
  ds_read_b64_tr_b16 v[130:131], v21 offset:21504
  ds_read_b64_tr_b16 v[132:133], v20 offset:18496
  ds_read_b64_tr_b16 v[134:135], v20 offset:21568
  ds_read_b64_tr_b16 v[136:137], v21 offset:18496
  ds_read_b64_tr_b16 v[138:139], v21 offset:21568
  ds_read_b64_tr_b16 v[140:141], v20 offset:18560
  ds_read_b64_tr_b16 v[142:143], v20 offset:21632
  s_waitcnt vmcnt(0)
  v_cmp_ne_u32 vcc, s62, v19
  s_cbranch_vccz Lof_21
  s_mov_b32 s33, 32768
Lof_22:
  s_sub_u32 s33, s33, 1
  s_cbranch_scc1 Lof_23
  buffer_load_dword v19, v14, s[8:11], 0 offen sc1
  s_waitcnt vmcnt(0)
  v_cmp_ne_u32 vcc, s62, v19
  s_cbranch_vccnz Lof_22
Lof_23:
Lof_21:
  s_waitcnt lgkmcnt(0)
  s_mov_b32 s32, 4096
Le4_24:
  s_mov_b32 s33, 64
Le4_27:
  s_sub_u32 s33, s33, 1
  s_cbranch_scc1 Le4_26
  buffer_load_dwordx4 v[32:35], v15, s[8:11], 0 offen offset:0 sc1
  buffer_load_dwordx4 v[36:39], v15, s[8:11], 0 offen offset:64 sc1
  buffer_load_dwordx4 v[40:43], v15, s[8:11], 0 offen offset:128 sc1
  buffer_load_dwordx4 v[44:47], v15, s[8:11], 0 offen offset:192 sc1
  s_waitcnt vmcnt(0)
  v_mfma_f32_16x16x32_bf16 v[144:147], v[32:35], v[64:67], 0
  v_max3_u32 v19, v32, v33, v34
  v_max3_u32 v19, v19, v35, v36
  v_max3_u32 v19, v19, v37, v38
  v_mfma_f32_16x16x32_bf16 v[148:151], v[32:35], v[68:71], 0
  v_max3_u32 v19, v19, v39, v40
  v_max3_u32 v19, v19, v41, v42
  v_max3_u32 v19, v19, v43, v44
  v_mfma_f32_16x16x32_bf16 v[152:155], v[32:35], v[72:75], 0
  v_max3_u32 v19, v19, v45, v46
  v_max_u32 v19, v19, v47
  v_cmp_eq_u32 vcc, -1, v19
  v_mfma_f32_16x16x32_bf16 v[156:159], v[32:35], v[76:79], 0
  s_cbranch_vccnz Le4_27
Le4_25:
  v_mfma_f32_16x16x32_bf16 v[160:163], v[32:35], v[80:83], 0
  v_mfma_f32_16x16x32_bf16 v[144:147], v[36:39], v[84:87], v[144:147]
  v_mfma_f32_16x16x32_bf16 v[148:151], v[36:39], v[88:91], v[148:151]
  v_mfma_f32_16x16x32_bf16 v[152:155], v[36:39], v[92:95], v[152:155]
  v_mfma_f32_16x16x32_bf16 v[156:159], v[36:39], v[96:99], v[156:159]
  v_mfma_f32_16x16x32_bf16 v[160:163], v[36:39], v[100:103], v[160:163]
  v_mfma_f32_16x16x32_bf16 v[144:147], v[40:43], v[104:107], v[144:147]
  v_mfma_f32_16x16x32_bf16 v[148:151], v[40:43], v[108:111], v[148:151]
  v_mfma_f32_16x16x32_bf16 v[152:155], v[40:43], v[112:115], v[152:155]
  v_mfma_f32_16x16x32_bf16 v[156:159], v[40:43], v[116:119], v[156:159]
  v_mfma_f32_16x16x32_bf16 v[160:163], v[40:43], v[120:123], v[160:163]
  v_mfma_f32_16x16x32_bf16 v[144:147], v[44:47], v[124:127], v[144:147]
  v_mfma_f32_16x16x32_bf16 v[148:151], v[44:47], v[128:131], v[148:151]
  v_mfma_f32_16x16x32_bf16 v[152:155], v[44:47], v[132:135], v[152:155]
  v_mfma_f32_16x16x32_bf16 v[156:159], v[44:47], v[136:139], v[156:159]
  v_mfma_f32_16x16x32_bf16 v[160:163], v[44:47], v[140:143], v[160:163]
  s_nop 3
  v_add_f32 v144, v144, v145
  v_add_f32 v146, v146, v147
  v_add_f32 v148, v148, v149
  v_add_f32 v150, v150, v151
  v_add_f32 v152, v152, v153
  v_add_f32 v154, v154, v155
  v_add_f32 v156, v156, v157
  v_add_f32 v158, v158, v159
  v_add_f32 v160, v160, v161
  v_add_f32 v162, v162, v163
  s_mov_b64 exec, 0xffff
  v_add_f32 v144, v144, v146
  ds_write_b32 v16, v144 offset:36864
  v_add_f32 v148, v148, v150
  ds_write_b32 v16, v148 offset:37120
  v_add_f32 v152, v152, v154
  ds_write_b32 v16, v152 offset:37376
  v_add_f32 v156, v156, v158
  ds_write_b32 v16, v156 offset:37632
  v_add_f32 v160, v160, v162
  ds_write_b32 v16, v160 offset:37888
  s_mov_b64 exec, -1
  s_waitcnt lgkmcnt(0)
  s_barrier
  ds_read_b128 v[52:55], v17 offset:0x9000
  ds_read_b128 v[56:59], v17 offset:0x9010
  s_waitcnt lgkmcnt(1)
  v_pk_add_f32 v[52:53], v[52:53], v[54:55]
  s_waitcnt lgkmcnt(0)
  v_pk_add_f32 v[56:57], v[56:57], v[58:59]
  v_add_f32 v52, v52, v53
  v_add_f32 v56, v56, v57
  v_cvt_pk_bf16_f32 v52, v52, v56
  buffer_store_dword v52, v18, s[8:11], 0 offen sc1
  buffer_store_dword v52, v18, s[8:11], s31 offen sc1
  s_endpgm
Le4_26:
  buffer_load_dwordx4 v[32:35], v15, s[8:11], s35 offen offset:0 sc1
  buffer_load_dwordx4 v[36:39], v15, s[8:11], s35 offen offset:64 sc1
  buffer_load_dwordx4 v[40:43], v15, s[8:11], s35 offen offset:128 sc1
  buffer_load_dwordx4 v[44:47], v15, s[8:11], s35 offen offset:192 sc1
  s_waitcnt vmcnt(0)
  v_mfma_f32_16x16x32_bf16 v[144:147], v[32:35], v[64:67], 0
  v_max3_u32 v19, v32, v33, v34
  v_max3_u32 v19, v19, v35, v36
  v_max3_u32 v19, v19, v37, v38
  v_mfma_f32_16x16x32_bf16 v[148:151], v[32:35], v[68:71], 0
  v_max3_u32 v19, v19, v39, v40
  v_max3_u32 v19, v19, v41, v42
  v_max3_u32 v19, v19, v43, v44
  v_mfma_f32_16x16x32_bf16 v[152:155], v[32:35], v[72:75], 0
  v_max3_u32 v19, v19, v45, v46
  v_max_u32 v19, v19, v47
  v_cmp_eq_u32 vcc, -1, v19
  v_mfma_f32_16x16x32_bf16 v[156:159], v[32:35], v[76:79], 0
  s_cbranch_vccz Le4_25
  s_sub_u32 s32, s32, 1
  s_cbranch_scc0 Le4_24
  s_branch Le4_25
Le1_19:
  buffer_load_dwordx4 v[20:23], v16, s[8:11], s35 offen sc1
  buffer_load_dwordx4 v[24:27], v16, s[8:11], s35 offen offset:16 sc1
  s_waitcnt vmcnt(0)
  v_xor_b32 v46, s62, v21
  v_xor_b32 v47, s62, v23
  v_xor_b32 v28, s62, v25
  v_xor_b32 v29, s62, v27
  v_or3_b32 v46, v46, v47, v28
  v_or_b32 v46, v46, v29
  v_cmp_ne_u32 vcc, 0, v46
  s_cbranch_vccz Le1_18
  s_sub_u32 s32, s32, 1
  s_cbranch_scc0 Le1_17
  s_branch Le1_18
LFZ:
  s_cmp_ge_u32 s63, 54
  s_cbranch_scc1 LZ
  s_mov_b32 s16, s50
  s_mov_b32 s17, s51
  s_mov_b32 s18, 2211840
  s_mov_b32 s19, 0x20000
  s_mov_b32 s20, s52
  s_mov_b32 s21, s53
  s_mov_b32 s22, 2211840
  s_mov_b32 s23, 0x20000
  s_mov_b32 s24, s54
  s_mov_b32 s25, s55
  s_mov_b32 s26, 2211840
  s_mov_b32 s27, 0x20000
  s_mul_i32 s31, s3, 552960
  s_lshl_b32 s34, s63, 6
  s_add_u32 s31, s31, s34
  s_mul_i32 s34, s3, 20480
  s_add_u32 s34, s34, 40960
  s_mov_b32 s30, s34
  v_lshrrev_b32 v12, 2, v1
  v_mul_u32_u24 v12, 3456, v12
  v_and_b32 v13, 3, v1
  v_lshl_add_u32 v12, v13, 4, v12
  s_mov_b32 s32, 4096
Le1_28:
  s_mov_b32 s33, 64
Le1_31:
  s_sub_u32 s33, s33, 1
  s_cbranch_scc1 Le1_30
  buffer_load_dwordx4 v[20:23], v16, s[8:11], 0 offen sc1
  buffer_load_dwordx4 v[24:27], v16, s[8:11], 0 offen offset:16 sc1
  s_waitcnt vmcnt(0)
  v_xor_b32 v46, s62, v21
  v_xor_b32 v47, s62, v23
  v_xor_b32 v28, s62, v25
  v_xor_b32 v29, s62, v27
  v_or3_b32 v46, v46, v47, v28
  v_or_b32 v46, v46, v29
  v_cmp_ne_u32 vcc, 0, v46
  s_cbranch_vccnz Le1_31
Le1_29:
  ds_write2_b32 v45, v20, v22 offset0:0 offset1:1
  ds_write2_b32 v45, v24, v26 offset0:2 offset1:3
  s_waitcnt lgkmcnt(0)
  s_barrier
  ds_read_b128 v[128:131], v44 offset:32768
  ds_read_b128 v[132:135], v44 offset:33792
  ds_read_b128 v[136:139], v44 offset:34816
  ds_read_b128 v[140:143], v44 offset:35840
  s_waitcnt lgkmcnt(3)
  v_mfma_f32_16x16x32_bf16 v[48:51], v[128:131], v[64:67], 0
  v_mfma_f32_16x16x32_bf16 v[52:55], v[128:131], v[80:83], 0
  s_waitcnt lgkmcnt(2)
  v_mfma_f32_16x16x32_bf16 v[48:51], v[132:135], v[68:71], v[48:51]
  v_mfma_f32_16x16x32_bf16 v[52:55], v[132:135], v[84:87], v[52:55]
  s_waitcnt lgkmcnt(1)
  v_mfma_f32_16x16x32_bf16 v[48:51], v[136:139], v[72:75], v[48:51]
  v_mfma_f32_16x16x32_bf16 v[52:55], v[136:139], v[88:91], v[52:55]
  s_waitcnt lgkmcnt(0)
  v_mfma_f32_16x16x32_bf16 v[48:51], v[140:143], v[76:79], v[48:51]
  v_mfma_f32_16x16x32_bf16 v[52:55], v[140:143], v[92:95], v[52:55]
  s_nop 6
  v_add_f32 v48, v48, v49
  v_add_f32 v50, v50, v51
  v_add_f32 v52, v52, v53
  v_add_f32 v54, v54, v55
  v_add_f32 v48, v48, v50
  v_add_f32 v52, v52, v54
  s_nop 1
  v_permlane32_swap_b32 v48, v52
  v_add_f32 v48, v48, v52
  v_mov_b32 v49, v48
  s_nop 1
  v_permlane16_swap_b32 v48, v49
  v_add_f32 v48, v48, v49
  v_mul_f32 v48, 0x3e0293ee, v48
  v_mov_b32 v49, v48
  s_nop 1
  v_permlane32_swap_b32 v48, v49
  v_cvt_pk_bf16_f32 v48, v48, v49
  buffer_store_dword v48, v18, s[8:11], 0 offen sc1
  s_mov_b32 s46, 4194304
  s_mov_b32 s47, 0x20000
  buffer_load_dword v116, v115, s[44:47], 0 offen offset:0
  s_mov_b32 m0, s34
  s_add_u32 s34, s34, 1024
  buffer_load_dwordx4 v12, s[16:19], s31 offen  lds
  s_mov_b32 m0, s34
  s_add_u32 s34, s34, 1024
  buffer_load_dwordx4 v12, s[20:23], s31 offen  lds
  s_add_u32 s31, s31, 55296
  s_mov_b32 m0, s34
  s_add_u32 s34, s34, 1024
  buffer_load_dwordx4 v12, s[16:19], s31 offen  lds
  s_mov_b32 m0, s34
  s_add_u32 s34, s34, 1024
  buffer_load_dwordx4 v12, s[20:23], s31 offen  lds
  s_add_u32 s31, s31, 55296
  s_mov_b32 m0, s34
  s_add_u32 s34, s34, 1024
  buffer_load_dwordx4 v12, s[16:19], s31 offen  lds
  s_mov_b32 m0, s34
  s_add_u32 s34, s34, 1024
  buffer_load_dwordx4 v12, s[20:23], s31 offen  lds
  s_add_u32 s31, s31, 55296
  s_mov_b32 m0, s34
  s_add_u32 s34, s34, 1024
  buffer_load_dwordx4 v12, s[16:19], s31 offen  lds
  s_mov_b32 m0, s34
  s_add_u32 s34, s34, 1024
  buffer_load_dwordx4 v12, s[20:23], s31 offen  lds
  s_add_u32 s31, s31, 55296
  s_mov_b32 m0, s34
  s_add_u32 s34, s34, 1024
  buffer_load_dwordx4 v12, s[16:19], s31 offen  lds
  s_mov_b32 m0, s34
  s_add_u32 s34, s34, 1024
  buffer_load_dwordx4 v12, s[20:23], s31 offen  lds
  s_add_u32 s31, s31, 55296
  s_mov_b32 m0, s34
  s_add_u32 s34, s34, 1024
  buffer_load_dwordx4 v12, s[16:19], s31 offen  lds
  s_mov_b32 m0, s34
  s_add_u32 s34, s34, 1024
  buffer_load_dwordx4 v12, s[20:23], s31 offen  lds
  s_add_u32 s31, s31, 55296
  s_mov_b32 m0, s34
  s_add_u32 s34, s34, 1024
  buffer_load_dwordx4 v12, s[16:19], s31 offen  lds
  s_mov_b32 m0, s34
  s_add_u32 s34, s34, 1024
  buffer_load_dwordx4 v12, s[20:23], s31 offen  lds
  s_add_u32 s31, s31, 55296
  s_mov_b32 m0, s34
  s_add_u32 s34, s34, 1024
  buffer_load_dwordx4 v12, s[16:19], s31 offen  lds
  s_mov_b32 m0, s34
  s_add_u32 s34, s34, 1024
  buffer_load_dwordx4 v12, s[20:23], s31 offen  lds
  s_add_u32 s31, s31, 55296
  s_mov_b32 m0, s34
  s_add_u32 s34, s34, 1024
  buffer_load_dwordx4 v12, s[16:19], s31 offen  lds
  s_mov_b32 m0, s34
  s_add_u32 s34, s34, 1024
  buffer_load_dwordx4 v12, s[20:23], s31 offen  lds
  s_add_u32 s31, s31, 55296
  s_mov_b32 m0, s34
  s_add_u32 s34, s34, 1024
  buffer_load_dwordx4 v12, s[16:19], s31 offen  lds
  s_mov_b32 m0, s34
  s_add_u32 s34, s34, 1024
  buffer_load_dwordx4 v12, s[20:23], s31 offen  lds
  v_lshrrev_b32 v17, 1, v2
  v_lshlrev_b32 v17, 11, v17
  v_and_b32 v18, 1, v2
  v_lshl_add_u32 v17, v18, 9, v17
  v_lshrrev_b32 v18, 2, v3
  v_lshl_add_u32 v17, v18, 6, v17
  v_lshl_add_u32 v17, v13, 3, v17
  v_add_u32 v17, s30, v17
  s_lshl_b32 s34, s3, 11
  s_add_u32 s34, s34, 4096
  v_lshl_add_u32 v18, v3, 7, s34
  s_lshl_b32 s34, s3, 9
  s_add_u32 s34, s34, 917504
  s_mul_i32 s35, s4, 16384
  s_add_u32 s34, s34, s35
  v_lshl_add_u32 v20, v3, 11, s34
  v_lshl_add_u32 v20, v2, 4, v20
  v_lshrrev_b32 v21, 1, v2
  v_mul_u32_u24 v21, 96, v21
  v_add_u32 v21, v21, v20
  v_mul_u32_u24 v22, 80, v3
  s_lshl_b32 s34, s3, 4
  v_lshl_add_u32 v23, v2, 2, s34
  v_add_u32 v23, v23, v22
  v_and_b32 v24, 7, v3
  v_lshl_add_u32 v24, v2, 3, v24
  v_lshrrev_b32 v25, 3, v3
  v_lshl_add_u32 v24, v25, 5, v24
  v_mul_u32_u24 v24, 80, v24
  s_lshl_b32 s34, s3, 8
  s_add_u32 s34, s34, s96
  v_lshlrev_b32 v26, 4, v3
  v_lshl_add_u32 v26, v2, 3, v26
  s_add_u32 s35, s96, 1024
  v_add_u32 v27, s35, v26
  v_add_u32 v26, s34, v26
  v_mov_b32 v29, v6
  v_cmp_gt_u32 vcc, 32, v1
  s_nop 1
  v_cndmask_b32 v26, v6, v26, vcc
  v_cmp_gt_u32 vcc, 32, v0
  s_nop 1
  v_cndmask_b32 v27, v6, v27, vcc
  buffer_load_dword v19, v18, s[8:11], 0 offen sc1
  s_mul_i32 s31, s63, 40960
  v_mul_u32_u24 v14, 10240, v2
  v_lshl_add_u32 v14, v3, 4, v14
  v_add_u32 v15, 1024, v14
  s_lshl_b32 s34, s3, 8
  v_add_u32 v14, s34, v14
  v_cmp_gt_u32 vcc, 64, v0
  s_nop 1
  v_cndmask_b32 v15, v6, v15, vcc
  s_add_u32 s33, s31, 3840
  s_add_u32 s32, s31, 7680
  buffer_load_dwordx4 v[160:163], v14, s[24:27], s31 offen offset:0
  buffer_load_dwordx4 v[164:167], v14, s[24:27], s31 offen offset:1280
  buffer_load_dwordx4 v[168:171], v14, s[24:27], s31 offen offset:2560
  buffer_load_dwordx4 v[172:175], v14, s[24:27], s33 offen offset:0
  buffer_load_dwordx4 v[176:179], v14, s[24:27], s33 offen offset:1280
  buffer_load_dwordx4 v[180:183], v14, s[24:27], s33 offen offset:2560
  buffer_load_dwordx4 v[184:187], v14, s[24:27], s32 offen offset:0
  buffer_load_dwordx4 v[188:191], v14, s[24:27], s32 offen offset:1280
  s_cmp_lg_u32 s3, 0
  s_cbranch_scc1 Lw_32
  buffer_load_dwordx4 v[192:195], v15, s[24:27], s31 offen offset:0
  buffer_load_dwordx4 v[196:199], v15, s[24:27], s31 offen offset:1280
  buffer_load_dwordx4 v[200:203], v15, s[24:27], s31 offen offset:2560
  buffer_load_dwordx4 v[204:207], v15, s[24:27], s33 offen offset:0
  buffer_load_dwordx4 v[208:211], v15, s[24:27], s33 offen offset:1280
  buffer_load_dwordx4 v[212:215], v15, s[24:27], s33 offen offset:2560
  buffer_load_dwordx4 v[216:219], v15, s[24:27], s32 offen offset:0
  buffer_load_dwordx4 v[220:223], v15, s[24:27], s32 offen offset:1280
Lw_32:
  s_mul_i32 s34, s3, 320
  v_lshl_add_u32 v16, v2, 4, s34
  v_cmp_eq_u32 vcc, 8, v3
  s_nop 1
  v_cndmask_b32 v16, v6, v16, vcc
  buffer_load_dwordx4 v[40:43], v16, s[12:15], 0 offen offset:0
  buffer_load_dwordx4 v[44:47], v16, s[12:15], 0 offen offset:64
  buffer_load_dwordx4 v[48:51], v16, s[12:15], 0 offen offset:128
  buffer_load_dwordx4 v[52:55], v16, s[12:15], 0 offen offset:192
  buffer_load_dwordx4 v[56:59], v16, s[12:15], 0 offen offset:256
  s_waitcnt vmcnt(14)
  ds_read_b64_tr_b16 v[64:65], v17 offset:0
  ds_read_b64_tr_b16 v[66:67], v17 offset:256
  ds_read_b64_tr_b16 v[68:69], v17 offset:32
  ds_read_b64_tr_b16 v[70:71], v17 offset:288
  ds_read_b64_tr_b16 v[72:73], v17 offset:1024
  ds_read_b64_tr_b16 v[74:75], v17 offset:1280
  ds_read_b64_tr_b16 v[76:77], v17 offset:1056
  ds_read_b64_tr_b16 v[78:79], v17 offset:1312
  ds_read_b64_tr_b16 v[80:81], v17 offset:4096
  ds_read_b64_tr_b16 v[82:83], v17 offset:4352
  ds_read_b64_tr_b16 v[84:85], v17 offset:4128
  ds_read_b64_tr_b16 v[86:87], v17 offset:4384
  ds_read_b64_tr_b16 v[88:89], v17 offset:5120
  ds_read_b64_tr_b16 v[90:91], v17 offset:5376
  ds_read_b64_tr_b16 v[92:93], v17 offset:5152
  ds_read_b64_tr_b16 v[94:95], v17 offset:5408
  ds_read_b64_tr_b16 v[96:97], v17 offset:8192
  ds_read_b64_tr_b16 v[98:99], v17 offset:8448
  ds_read_b64_tr_b16 v[100:101], v17 offset:8224
  ds_read_b64_tr_b16 v[102:103], v17 offset:8480
  ds_read_b64_tr_b16 v[104:105], v17 offset:9216
  ds_read_b64_tr_b16 v[106:107], v17 offset:9472
  ds_read_b64_tr_b16 v[108:109], v17 offset:9248
  ds_read_b64_tr_b16 v[110:111], v17 offset:9504
  ds_read_b64_tr_b16 v[112:113], v17 offset:12288
  ds_read_b64_tr_b16 v[114:115], v17 offset:12544
  ds_read_b64_tr_b16 v[116:117], v17 offset:12320
  ds_read_b64_tr_b16 v[118:119], v17 offset:12576
  ds_read_b64_tr_b16 v[120:121], v17 offset:13312
  ds_read_b64_tr_b16 v[122:123], v17 offset:13568
  ds_read_b64_tr_b16 v[124:125], v17 offset:13344
  ds_read_b64_tr_b16 v[126:127], v17 offset:13600
  ds_read_b64_tr_b16 v[128:129], v17 offset:16384
  ds_read_b64_tr_b16 v[130:131], v17 offset:16640
  ds_read_b64_tr_b16 v[132:133], v17 offset:16416
  ds_read_b64_tr_b16 v[134:135], v17 offset:16672
  ds_read_b64_tr_b16 v[136:137], v17 offset:17408
  ds_read_b64_tr_b16 v[138:139], v17 offset:17664
  ds_read_b64_tr_b16 v[140:141], v17 offset:17440
  ds_read_b64_tr_b16 v[142:143], v17 offset:17696
  s_waitcnt vmcnt(0)
  v_mov_b32 v28, 0x3f803f80
  v_cmp_eq_u32 vcc, 12, v3
  s_nop 1
  v_cndmask_b32 v40, v40, v28, vcc
  v_cndmask_b32 v41, v41, v28, vcc
  v_cndmask_b32 v42, v42, v28, vcc
  v_cndmask_b32 v43, v43, v28, vcc
  v_cndmask_b32 v44, v44, v28, vcc
  v_cndmask_b32 v45, v45, v28, vcc
  v_cndmask_b32 v46, v46, v28, vcc
  v_cndmask_b32 v47, v47, v28, vcc
  v_cndmask_b32 v48, v48, v28, vcc
  v_cndmask_b32 v49, v49, v28, vcc
  v_cndmask_b32 v50, v50, v28, vcc
  v_cndmask_b32 v51, v51, v28, vcc
  v_cndmask_b32 v52, v52, v28, vcc
  v_cndmask_b32 v53, v53, v28, vcc
  v_cndmask_b32 v54, v54, v28, vcc
  v_cndmask_b32 v55, v55, v28, vcc
  v_cndmask_b32 v56, v56, v28, vcc
  v_cndmask_b32 v57, v57, v28, vcc
  v_cndmask_b32 v58, v58, v28, vcc
  v_cndmask_b32 v59, v59, v28, vcc
  v_cmp_gt_u32 s[98:99], 9, v3
  s_waitcnt vmcnt(0)
  v_cmp_ne_u32 vcc, s62, v19
  s_cbranch_vccz Lff_33
  s_mov_b32 s33, 32768
Lff_34:
  s_sub_u32 s33, s33, 1
  s_cbranch_scc1 Lff_35
  buffer_load_dword v19, v18, s[8:11], 0 offen sc1
  s_waitcnt vmcnt(0)
  v_cmp_ne_u32 vcc, s62, v19
  s_cbranch_vccnz Lff_34
Lff_35:
Lff_33:
  s_waitcnt lgkmcnt(0)
  s_mov_b32 exec_lo, 0x00ff00ff
  s_mov_b32 exec_hi, 0x00ff00ff
  s_mov_b32 s33, 32768
Le5_36:
  s_sub_u32 s33, s33, 1
  s_cbranch_scc1 Le5_37
  buffer_load_dwordx4 v[40:43], v20, s[8:11], 0 offen offset:0 sc1
  buffer_load_dwordx4 v[44:47], v20, s[8:11], 0 offen offset:64 sc1
  buffer_load_dwordx4 v[48:51], v21, s[8:11], 0 offen offset:128 sc1
  buffer_load_dwordx4 v[52:55], v20, s[8:11], 0 offen offset:288 sc1
  buffer_load_dwordx4 v[56:59], v20, s[8:11], 0 offen offset:352 sc1
  s_waitcnt vmcnt(0)
  v_mfma_f32_16x16x32_bf16 v[224:227], v[40:43], v[64:67], 0
  v_max3_u32 v19, v40, v41, v42
  v_max3_u32 v19, v19, v43, v44
  v_max3_u32 v19, v19, v45, v46
  v_mfma_f32_16x16x32_bf16 v[228:231], v[40:43], v[68:71], 0
  v_max3_u32 v19, v19, v47, v48
  v_max3_u32 v19, v19, v49, v50
  v_max3_u32 v19, v19, v51, v52
  v_mfma_f32_16x16x32_bf16 v[232:235], v[40:43], v[72:75], 0
  v_max3_u32 v19, v19, v53, v54
  v_max3_u32 v19, v19, v55, v56
  v_max3_u32 v19, v19, v57, v58
  v_mfma_f32_16x16x32_bf16 v[236:239], v[40:43], v[76:79], 0
  v_max_u32 v19, v19, v59
  v_cmp_eq_u32 vcc, -1, v19
  s_cbranch_vccnz Le5_36
Le5_37:
  s_mov_b64 exec, -1
  v_mfma_f32_16x16x32_bf16 v[240:243], v[40:43], v[40:43], 0
  v_mfma_f32_16x16x32_bf16 v[224:227], v[44:47], v[80:83], v[224:227]
  v_mfma_f32_16x16x32_bf16 v[228:231], v[44:47], v[84:87], v[228:231]
  v_mfma_f32_16x16x32_bf16 v[232:235], v[44:47], v[88:91], v[232:235]
  v_mfma_f32_16x16x32_bf16 v[236:239], v[44:47], v[92:95], v[236:239]
  v_mfma_f32_16x16x32_bf16 v[240:243], v[44:47], v[44:47], v[240:243]
  v_mfma_f32_16x16x32_bf16 v[224:227], v[48:51], v[96:99], v[224:227]
  v_mfma_f32_16x16x32_bf16 v[228:231], v[48:51], v[100:103], v[228:231]
  v_mfma_f32_16x16x32_bf16 v[232:235], v[48:51], v[104:107], v[232:235]
  v_mfma_f32_16x16x32_bf16 v[236:239], v[48:51], v[108:111], v[236:239]
  v_mfma_f32_16x16x32_bf16 v[240:243], v[48:51], v[48:51], v[240:243]
  v_mfma_f32_16x16x32_bf16 v[224:227], v[52:55], v[112:115], v[224:227]
  v_mfma_f32_16x16x32_bf16 v[228:231], v[52:55], v[116:119], v[228:231]
  v_mfma_f32_16x16x32_bf16 v[232:235], v[52:55], v[120:123], v[232:235]
  v_mfma_f32_16x16x32_bf16 v[236:239], v[52:55], v[124:127], v[236:239]
  v_mfma_f32_16x16x32_bf16 v[240:243], v[52:55], v[52:55], v[240:243]
  v_mfma_f32_16x16x32_bf16 v[224:227], v[56:59], v[128:131], v[224:227]
  v_mfma_f32_16x16x32_bf16 v[228:231], v[56:59], v[132:135], v[228:231]
  v_mfma_f32_16x16x32_bf16 v[232:235], v[56:59], v[136:139], v[232:235]
  v_mfma_f32_16x16x32_bf16 v[236:239], v[56:59], v[140:143], v[236:239]
  v_mfma_f32_16x16x32_bf16 v[240:243], v[56:59], v[56:59], v[240:243]
  s_nop 3
  v_add_f32 v224, v224, v225
  v_add_f32 v226, v226, v227
  v_add_f32 v224, v224, v226
  ds_write_b32 v23, v224 offset:0
  v_add_f32 v228, v228, v229
  v_add_f32 v230, v230, v231
  v_add_f32 v228, v228, v230
  ds_write_b32 v23, v228 offset:1280
  v_add_f32 v232, v232, v233
  v_add_f32 v234, v234, v235
  v_add_f32 v232, v232, v234
  ds_write_b32 v23, v232 offset:2560
  v_add_f32 v236, v236, v237
  v_add_f32 v238, v238, v239
  v_add_f32 v236, v236, v238
  ds_write_b32 v23, v236 offset:3840
  v_add_f32 v240, v240, v241
  v_add_f32 v242, v242, v243
  v_add_f32 v240, v240, v242
  ds_write_b32 v23, v240 offset:5120
  s_waitcnt lgkmcnt(0)
  s_barrier
  ds_read_b128 v[80:83], v22 offset:5120
  ds_read_b128 v[84:87], v22 offset:5136
  ds_read_b128 v[88:91], v22 offset:5152
  ds_read_b128 v[92:95], v22 offset:5168
  ds_read_b128 v[64:67], v24 offset:0
  ds_read_b128 v[68:71], v24 offset:16
  ds_read_b128 v[72:75], v24 offset:32
  ds_read_b128 v[76:79], v24 offset:48
  s_waitcnt lgkmcnt(4)
  v_pk_add_f32 v[80:81], v[80:81], v[84:85]
  v_pk_add_f32 v[82:83], v[82:83], v[86:87]
  v_pk_add_f32 v[88:89], v[88:89], v[92:93]
  v_pk_add_f32 v[90:91], v[90:91], v[94:95]
  v_pk_add_f32 v[80:81], v[80:81], v[88:89]
  v_pk_add_f32 v[82:83], v[82:83], v[90:91]
  v_add_f32 v80, v80, v81
  v_add_f32 v80, v80, v82
  v_cndmask_b32 v81, 0, v80, s[98:99]
  s_nop 0
  v_mov_b32_dpp v82, v80 row_newbcast:12 row_mask:0xf bank_mask:0xf
  s_waitcnt lgkmcnt(0)
  v_pk_add_f32 v[64:65], v[64:65], v[68:69]
  v_pk_add_f32 v[66:67], v[66:67], v[70:71]
  v_pk_add_f32 v[72:73], v[72:73], v[76:77]
  v_pk_add_f32 v[74:75], v[74:75], v[78:79]
  v_pk_add_f32 v[64:65], v[64:65], v[72:73]
  v_pk_add_f32 v[66:67], v[66:67], v[74:75]
  v_add_f32 v64, v64, v65
  v_add_f32 v64, v64, v66
  v_add_f32_dpp v81, v81, v81 row_ror:8 row_mask:0xf bank_mask:0xf
  s_nop 1
  v_add_f32_dpp v81, v81, v81 row_ror:4 row_mask:0xf bank_mask:0xf
  s_nop 1
  v_add_f32_dpp v81, v81, v81 row_ror:2 row_mask:0xf bank_mask:0xf
  s_nop 1
  v_add_f32_dpp v81, v81, v81 row_ror:1 row_mask:0xf bank_mask:0xf
  v_mul_f32 v82, 0x3acccccd, v82
  v_mul_f32 v81, 0x3acccccd, v81
  v_fma_f32 v64, -v82, v67, v64
  v_fma_f32 v81, -v82, v82, v81
  v_max_f32 v81, 0, v81
  v_add_f32 v81, 0x3727c5ac, v81
  v_rsq_f32 v81, v81
  v_mov_b32 v66, 0xc0135761
  v_mul_f32 v64, v64, v81
  v_mul_f32 v65, v64, v64
  v_fmac_f32 v66, 0xbdd2d3e8, v65
  v_mul_f32 v66, v66, v64
  v_exp_f32 v66, v66
  v_mul_f32_dpp v65, v64, v64 row_ror:8 row_mask:0xf bank_mask:0xf
  v_add_f32 v66, 1.0, v66
  v_rcp_f32 v66, v66
  s_nop 0
  v_mul_f32 v66, v66, v65
  v_cvt_pk_bf16_f32 v66, v66, v66
  s_nop 1
  v_and_b32_dpp v96, v66, v32 row_newbcast:0 row_mask:0xf bank_mask:0xf
  v_and_b32_dpp v97, v66, v33 row_newbcast:0 row_mask:0xf bank_mask:0xf
  v_and_b32_dpp v98, v66, v34 row_newbcast:0 row_mask:0xf bank_mask:0xf
  v_and_b32_dpp v99, v66, v35 row_newbcast:0 row_mask:0xf bank_mask:0xf
  v_and_b32_dpp v100, v66, v32 row_newbcast:1 row_mask:0xf bank_mask:0xf
  v_and_b32_dpp v101, v66, v33 row_newbcast:1 row_mask:0xf bank_mask:0xf
  v_and_b32_dpp v102, v66, v34 row_newbcast:1 row_mask:0xf bank_mask:0xf
  v_and_b32_dpp v103, v66, v35 row_newbcast:1 row_mask:0xf bank_mask:0xf
  v_mfma_f32_16x16x32_bf16 v[224:227], v[96:99], v[160:163], 0
  v_mfma_f32_16x16x32_bf16 v[228:231], v[96:99], v[192:195], 0
  v_and_b32_dpp v104, v66, v32 row_newbcast:2 row_mask:0xf bank_mask:0xf
  v_and_b32_dpp v105, v66, v33 row_newbcast:2 row_mask:0xf bank_mask:0xf
  v_and_b32_dpp v106, v66, v34 row_newbcast:2 row_mask:0xf bank_mask:0xf
  v_and_b32_dpp v107, v66, v35 row_newbcast:2 row_mask:0xf bank_mask:0xf
  v_mfma_f32_16x16x32_bf16 v[224:227], v[100:103], v[164:167], v[224:227]
  v_mfma_f32_16x16x32_bf16 v[228:231], v[100:103], v[196:199], v[228:231]
  v_and_b32_dpp v108, v66, v32 row_newbcast:3 row_mask:0xf bank_mask:0xf
  v_and_b32_dpp v109, v66, v33 row_newbcast:3 row_mask:0xf bank_mask:0xf
  v_and_b32_dpp v110, v66, v34 row_newbcast:3 row_mask:0xf bank_mask:0xf
  v_and_b32_dpp v111, v66, v35 row_newbcast:3 row_mask:0xf bank_mask:0xf
  v_mfma_f32_16x16x32_bf16 v[224:227], v[104:107], v[168:171], v[224:227]
  v_mfma_f32_16x16x32_bf16 v[228:231], v[104:107], v[200:203], v[228:231]
  v_and_b32_dpp v112, v66, v32 row_newbcast:4 row_mask:0xf bank_mask:0xf
  v_and_b32_dpp v113, v66, v33 row_newbcast:4 row_mask:0xf bank_mask:0xf
  v_and_b32_dpp v114, v66, v34 row_newbcast:4 row_mask:0xf bank_mask:0xf
  v_and_b32_dpp v115, v66, v35 row_newbcast:4 row_mask:0xf bank_mask:0xf
  v_mfma_f32_16x16x32_bf16 v[224:227], v[108:111], v[172:175], v[224:227]
  v_mfma_f32_16x16x32_bf16 v[228:231], v[108:111], v[204:207], v[228:231]
  v_and_b32_dpp v116, v66, v32 row_newbcast:5 row_mask:0xf bank_mask:0xf
  v_and_b32_dpp v117, v66, v33 row_newbcast:5 row_mask:0xf bank_mask:0xf
  v_and_b32_dpp v118, v66, v34 row_newbcast:5 row_mask:0xf bank_mask:0xf
  v_and_b32_dpp v119, v66, v35 row_newbcast:5 row_mask:0xf bank_mask:0xf
  v_mfma_f32_16x16x32_bf16 v[224:227], v[112:115], v[176:179], v[224:227]
  v_mfma_f32_16x16x32_bf16 v[228:231], v[112:115], v[208:211], v[228:231]
  v_and_b32_dpp v120, v66, v32 row_newbcast:6 row_mask:0xf bank_mask:0xf
  v_and_b32_dpp v121, v66, v33 row_newbcast:6 row_mask:0xf bank_mask:0xf
  v_and_b32_dpp v122, v66, v34 row_newbcast:6 row_mask:0xf bank_mask:0xf
  v_and_b32_dpp v123, v66, v35 row_newbcast:6 row_mask:0xf bank_mask:0xf
  v_mfma_f32_16x16x32_bf16 v[224:227], v[116:119], v[180:183], v[224:227]
  v_mfma_f32_16x16x32_bf16 v[228:231], v[116:119], v[212:215], v[228:231]
  v_and_b32_dpp v124, v66, v32 row_newbcast:7 row_mask:0xf bank_mask:0xf
  v_and_b32_dpp v125, v66, v33 row_newbcast:7 row_mask:0xf bank_mask:0xf
  v_and_b32_dpp v126, v66, v34 row_newbcast:7 row_mask:0xf bank_mask:0xf
  v_and_b32_dpp v127, v66, v35 row_newbcast:7 row_mask:0xf bank_mask:0xf
  v_mfma_f32_16x16x32_bf16 v[224:227], v[120:123], v[184:187], v[224:227]
  v_mfma_f32_16x16x32_bf16 v[228:231], v[120:123], v[216:219], v[228:231]
  v_mfma_f32_16x16x32_bf16 v[224:227], v[124:127], v[188:191], v[224:227]
  v_mfma_f32_16x16x32_bf16 v[228:231], v[124:127], v[220:223], v[228:231]
  s_nop 6
  v_cvt_pk_bf16_f32 v224, v224, v225
  v_cvt_pk_bf16_f32 v225, v226, v227
  buffer_store_dwordx2 v[224:225], v26, s[8:11], 0 offen sc1
  v_cvt_pk_bf16_f32 v228, v228, v229
  v_cvt_pk_bf16_f32 v229, v230, v231
  buffer_store_dwordx2 v[228:229], v27, s[8:11], 0 offen sc1
  s_endpgm
Le1_30:
  buffer_load_dwordx4 v[20:23], v16, s[8:11], s35 offen sc1
  buffer_load_dwordx4 v[24:27], v16, s[8:11], s35 offen offset:16 sc1
  s_waitcnt vmcnt(0)
  v_xor_b32 v46, s62, v21
  v_xor_b32 v47, s62, v23
  v_xor_b32 v28, s62, v25
  v_xor_b32 v29, s62, v27
  v_or3_b32 v46, v46, v47, v28
  v_or_b32 v46, v46, v29
  v_cmp_ne_u32 vcc, 0, v46
  s_cbranch_vccz Le1_29
  s_sub_u32 s32, s32, 1
  s_cbranch_scc0 Le1_28
  s_branch Le1_29
LZ:
  s_mov_b32 s32, 4096
Le1_38:
  s_mov_b32 s33, 64
Le1_41:
  s_sub_u32 s33, s33, 1
  s_cbranch_scc1 Le1_40
  buffer_load_dwordx4 v[20:23], v16, s[8:11], 0 offen sc1
  buffer_load_dwordx4 v[24:27], v16, s[8:11], 0 offen offset:16 sc1
  s_waitcnt vmcnt(0)
  v_xor_b32 v46, s62, v21
  v_xor_b32 v47, s62, v23
  v_xor_b32 v28, s62, v25
  v_xor_b32 v29, s62, v27
  v_or3_b32 v46, v46, v47, v28
  v_or_b32 v46, v46, v29
  v_cmp_ne_u32 vcc, 0, v46
  s_cbranch_vccnz Le1_41
Le1_39:
  ds_write2_b32 v45, v20, v22 offset0:0 offset1:1
  ds_write2_b32 v45, v24, v26 offset0:2 offset1:3
  s_waitcnt lgkmcnt(0)
  s_barrier
  ds_read_b128 v[128:131], v44 offset:32768
  ds_read_b128 v[132:135], v44 offset:33792
  ds_read_b128 v[136:139], v44 offset:34816
  ds_read_b128 v[140:143], v44 offset:35840
  s_waitcnt lgkmcnt(3)
  v_mfma_f32_16x16x32_bf16 v[48:51], v[128:131], v[64:67], 0
  v_mfma_f32_16x16x32_bf16 v[52:55], v[128:131], v[80:83], 0
  s_waitcnt lgkmcnt(2)
  v_mfma_f32_16x16x32_bf16 v[48:51], v[132:135], v[68:71], v[48:51]
  v_mfma_f32_16x16x32_bf16 v[52:55], v[132:135], v[84:87], v[52:55]
  s_waitcnt lgkmcnt(1)
  v_mfma_f32_16x16x32_bf16 v[48:51], v[136:139], v[72:75], v[48:51]
  v_mfma_f32_16x16x32_bf16 v[52:55], v[136:139], v[88:91], v[52:55]
  s_waitcnt lgkmcnt(0)
  v_mfma_f32_16x16x32_bf16 v[48:51], v[140:143], v[76:79], v[48:51]
  v_mfma_f32_16x16x32_bf16 v[52:55], v[140:143], v[92:95], v[52:55]
  s_nop 6
  v_add_f32 v48, v48, v49
  v_add_f32 v50, v50, v51
  v_add_f32 v52, v52, v53
  v_add_f32 v54, v54, v55
  v_add_f32 v48, v48, v50
  v_add_f32 v52, v52, v54
  s_nop 1
  v_permlane32_swap_b32 v48, v52
  v_add_f32 v48, v48, v52
  v_mov_b32 v49, v48
  s_nop 1
  v_permlane16_swap_b32 v48, v49
  v_add_f32 v48, v48, v49
  v_mul_f32 v48, 0x3e0293ee, v48
  v_mov_b32 v49, v48
  s_nop 1
  v_permlane32_swap_b32 v48, v49
  v_cvt_pk_bf16_f32 v48, v48, v49
  buffer_store_dword v48, v18, s[8:11], 0 offen sc1
  s_mov_b32 s46, 4194304
  s_mov_b32 s47, 0x20000
  buffer_load_dword v116, v115, s[44:47], 0 offen offset:0
  s_mov_b32 s24, s56
  s_mov_b32 s25, s57
  s_mov_b32 s26, 1280
  s_mov_b32 s27, 0x20000
  s_sub_u32 s63, s63, 54
  s_lshl_b32 s30, s63, 2
  s_add_u32 s30, s30, s3
  s_mul_i32 s31, s30, 52
  s_lshr_b32 s31, s31, 8
  s_lshl_b32 s34, s30, 5
  v_lshrrev_b32 v12, 1, v1
  v_and_b32 v13, 1, v1
  v_lshl_add_u32 v13, v13, 4, s34
  v_mul_u32_u24 v14, 1280, v12
  v_add_u32 v14, v14, v13
  v_add_u32 v14, 786432, v14
  v_add_u32 v15, 40960, v14
  s_mul_i32 s35, s31, 96
  s_add_u32 s35, s35, 917504
  s_mul_i32 s33, s4, 16384
  s_add_u32 s35, s35, s33
  v_lshl_add_u32 v16, v12, 11, s35
  v_add_u32 v16, v16, v13
  v_lshlrev_b32 v17, 4, v3
  v_lshl_add_u32 v17, v2, 3, v17
  v_add_u32 v17, s34, v17
  v_and_b32 v18, 0x2e, v1
  v_cmp_eq_u32 vcc, 0, v18
  s_nop 1
  v_cndmask_b32 v17, v6, v17, vcc
  v_cmp_gt_u32 vcc, 44, v1
  s_nop 1
  v_cndmask_b32 v15, v6, v15, vcc
  v_cmp_gt_u32 vcc, 16, v1
  s_nop 1
  v_cndmask_b32 v16, v6, v16, vcc
  v_cmp_gt_u32 vcc, 2, v1
  s_nop 1
  v_cndmask_b32 v13, v6, v13, vcc
  buffer_load_dwordx4 v[40:43], v13, s[12:15], 0 offen
  v_and_b32 v19, 7, v1
  v_lshrrev_b32 v20, 3, v1
  v_lshl_add_u32 v20, v19, 3, v20
  v_add_u32 v20, 64, v20
  s_lshl_b32 s35, s31, 3
  v_add_u32 v19, s35, v19
  v_cmp_gt_u32 vcc, 54, v1
  s_nop 1
  v_cndmask_b32 v19, v19, v20, vcc
  v_lshlrev_b32 v19, 7, v19
  v_add_u32 v19, 4096, v19
  v_mov_b32 v22, 0
  v_mov_b32 v23, s62
  s_lshl_b32 s35, s63, 8
  v_add_u32 v21, s35, v0
  v_cmp_eq_u32 vcc, 0, v21
  s_nop 1
  v_cndmask_b32 v22, v6, v22, vcc
  v_and_b32 v36, 0x3f803f80, v32
  v_and_b32 v37, 0x3f803f80, v33
  v_and_b32 v38, 0x3f803f80, v34
  v_and_b32 v39, 0x3f803f80, v35
  s_mov_b32 s33, 32768
Lzf_42:
  s_sub_u32 s33, s33, 1
  s_cbranch_scc1 Lzf_43
  buffer_load_dword v20, v19, s[8:11], 0 offen sc1
  s_waitcnt vmcnt(0)
  v_cmp_ne_u32 vcc, s62, v20
  s_cbranch_vccnz Lzf_42
Lzf_43:
  v_mfma_f32_16x16x32_bf16 v[56:59], v[36:39], v[40:43], 0
  s_mov_b32 s33, 32768
Le5z_44:
  s_sub_u32 s33, s33, 1
  s_cbranch_scc1 Le5z_45
  buffer_load_dwordx4 v[44:47], v16, s[8:11], 0 offen sc1
  s_waitcnt vmcnt(0)
  v_max3_u32 v20, v44, v45, v46
  v_max_u32 v20, v20, v47
  v_cmp_eq_u32 vcc, -1, v20
  s_cbranch_vccnz Le5z_44
Le5z_45:
  v_mfma_f32_16x16x32_bf16 v[56:59], v[36:39], v[44:47], v[56:59]
  s_mov_b32 s33, 32768
Le6_46:
  s_sub_u32 s33, s33, 1
  s_cbranch_scc1 Le6_47
  buffer_load_dwordx4 v[48:51], v14, s[8:11], 0 offen sc1
  buffer_load_dwordx4 v[52:55], v15, s[8:11], 0 offen sc1
  s_waitcnt vmcnt(0)
  v_mfma_f32_16x16x32_bf16 v[60:63], v[36:39], v[48:51], v[56:59]
  v_max3_u32 v20, v48, v49, v50
  v_max3_u32 v20, v20, v51, v52
  v_max3_u32 v20, v20, v53, v54
  v_mfma_f32_16x16x32_bf16 v[60:63], v[36:39], v[52:55], v[60:63]
  v_max_u32 v20, v20, v55
  v_cmp_eq_u32 vcc, -1, v20
  s_cbranch_vccnz Le6_46
Le6_47:
  s_nop 4
  v_add_f32_dpp v60, v60, v60 row_ror:8 row_mask:0xf bank_mask:0xf
  v_add_f32_dpp v61, v61, v61 row_ror:8 row_mask:0xf bank_mask:0xf
  v_add_f32_dpp v62, v62, v62 row_ror:8 row_mask:0xf bank_mask:0xf
  v_add_f32_dpp v63, v63, v63 row_ror:8 row_mask:0xf bank_mask:0xf
  v_add_f32_dpp v60, v60, v60 row_ror:4 row_mask:0xf bank_mask:0xf
  v_add_f32_dpp v61, v61, v61 row_ror:4 row_mask:0xf bank_mask:0xf
  v_add_f32_dpp v62, v62, v62 row_ror:4 row_mask:0xf bank_mask:0xf
  v_add_f32_dpp v63, v63, v63 row_ror:4 row_mask:0xf bank_mask:0xf
  v_add_f32_dpp v56, v60, v60 row_ror:2 row_mask:0xf bank_mask:0xf
  v_add_f32_dpp v57, v61, v61 row_ror:2 row_mask:0xf bank_mask:0xf
  v_add_f32_dpp v58, v62, v62 row_ror:2 row_mask:0xf bank_mask:0xf
  v_add_f32_dpp v59, v63, v63 row_ror:2 row_mask:0xf bank_mask:0xf
  v_cvt_pk_bf16_f32 v56, v56, v57
  v_cvt_pk_bf16_f32 v57, v58, v59
  buffer_store_dwordx2 v[56:57], v17, s[24:27], 0 offen
  buffer_store_dword v23, v22, s[8:11], 0 offen
  s_endpgm
Le1_40:
  buffer_load_dwordx4 v[20:23], v16, s[8:11], s35 offen sc1
  buffer_load_dwordx4 v[24:27], v16, s[8:11], s35 offen offset:16 sc1
  s_waitcnt vmcnt(0)
  v_xor_b32 v46, s62, v21
  v_xor_b32 v47, s62, v23
  v_xor_b32 v28, s62, v25
  v_xor_b32 v29, s62, v27
  v_or3_b32 v46, v46, v47, v28
  v_or_b32 v46, v46, v29
  v_cmp_ne_u32 vcc, 0, v46
  s_cbranch_vccz Le1_39
  s_sub_u32 s32, s32, 1
  s_cbranch_scc0 Le1_38
  s_branch Le1_39
LEND:
s_endpgm
.section .rodata,"a"
.p2align 6
.amdhsa_kernel sequential_preLN__compressed_kv_cla__glu_gated_geglu__decode_kernel
  .amdhsa_next_free_vgpr 512
  .amdhsa_next_free_sgpr 102
  .amdhsa_accum_offset 256
  .amdhsa_group_segment_fixed_size 0
  .amdhsa_kernarg_size 104
  .amdhsa_user_sgpr_count 2
  .amdhsa_user_sgpr_kernarg_segment_ptr 1
  .amdhsa_system_sgpr_workgroup_id_x 1
.end_amdhsa_kernel
```
